```python
import torch

def _softmax(x, axis=-1):
    return torch.softmax(x, dim=axis)

def _gelu(x):
    return torch.nn.functional.gelu(x, approximate='tanh')

def _silu(x):
    return torch.nn.functional.silu(x)

def _sigmoid(x):
    return torch.sigmoid(x)

def _layernorm(x, axis=-1, eps=1e-05):
    m = x.mean(dim=axis, keepdim=True)
    v = x.var(dim=axis, keepdim=True, unbiased=False)
    return (x - m) / torch.sqrt(v + eps)

def _scatter_add(tgt, idx, src, axis=0):
    return tgt.clone().index_add_(axis, idx, src)

def _segment_sum(src, seg, n):
    out = torch.zeros((n,) + src.shape[1:], dtype=src.dtype)
    return out.index_add_(0, seg, src)

def _pad(x, pw):
    flat = tuple((v for pair in reversed(pw) for v in pair))
    return torch.nn.functional.pad(x, flat)
kernel_name = 'standalone__tree_speculative_verify_tree_attention_over_candidate_token_tree__sampling'

def setup_inputs():

    _w = lambda a: (lambda t: t.to(torch.bfloat16) if t.is_floating_point() else t)(torch.as_tensor(a))
    B, Hq, Hkv, T, C, D = (16, 32, 8, 32, 4096, 128)
    tree_mask = torch.zeros((B, T, T), dtype=float)
    for b in range(B):
        parent = torch.zeros(T, dtype=torch.int64)
        for i in range(1, T):
            parent[i] = int(torch.randint(0, i, (1,)).item())
        for i in range(T):
            j = i
            tree_mask[b, i, j] = 1.0
            while j > 0:
                j = parent[j]
                tree_mask[b, i, j] = 1.0
    return {'q': _w((lambda *s: torch.randn(*s, dtype=torch.bfloat16) * 0.8)(B, Hq, T, D)), 'k_cache': _w((lambda *s: torch.randn(*s, dtype=torch.bfloat16) * 0.8)(B, Hkv, C, D)), 'v_cache': _w((lambda *s: torch.randn(*s, dtype=torch.bfloat16) * 0.05)(B, Hkv, C, D)), 'k_tree': _w((lambda *s: torch.randn(*s, dtype=torch.bfloat16) * 0.8)(B, Hkv, T, D)), 'v_tree': _w((lambda *s: torch.randn(*s, dtype=torch.bfloat16) * 0.05)(B, Hkv, T, D)), 'tree_mask': _w(tree_mask)}

def reference(q, k_cache, v_cache, k_tree, v_tree, tree_mask):
    B, Hq, T, D = q.shape
    Hkv, C = (k_cache.shape[1], k_cache.shape[2])
    rep = Hq // Hkv
    kc = (lambda x, n, axis: torch.repeat_interleave(x, n, dim=axis))(k_cache, rep, axis=1)
    vc = (lambda x, n, axis: torch.repeat_interleave(x, n, dim=axis))(v_cache, rep, axis=1)
    kt = (lambda x, n, axis: torch.repeat_interleave(x, n, dim=axis))(k_tree, rep, axis=1)
    vt = (lambda x, n, axis: torch.repeat_interleave(x, n, dim=axis))(v_tree, rep, axis=1)
    k = torch.concatenate([kc, kt], axis=2)
    v = torch.concatenate([vc, vt], axis=2)
    scale = D ** (-0.5)
    scores = torch.einsum('bhqd,bhkd->bhqk', q, k) * scale
    ctx_mask = torch.ones((B, 1, T, C), dtype=scores.dtype)
    tm = tree_mask[:, None, :, :].clone()
    full_mask = torch.concatenate([ctx_mask, tm], axis=-1)
    scores = scores + (1.0 - full_mask) * -1000000000.0
    p = _softmax(scores, axis=-1)
    return torch.einsum('bhqk,bhkd->bhqd', p, v)
```

```asm
; @launch grid=(256,1,1) block=(384,1,1) lds=135232
.amdgcn_target "amdgcn-amd-amdhsa--gfx950"
.text
.globl standalone__tree_speculative_verify_tree_attention_over_candidate_token_tree__sampling_kernel
.p2align 8
.type standalone__tree_speculative_verify_tree_attention_over_candidate_token_tree__sampling_kernel,@function
standalone__tree_speculative_verify_tree_attention_over_candidate_token_tree__sampling_kernel:
    s_cmp_ge_u32 s2, 256
    s_cbranch_scc1 L_end0
    s_load_dwordx16 s[4:19], s[0:1], 0
    s_load_dwordx2 s[20:21], s[0:1], 64
    v_lshrrev_b32 v1, 6, v0
    v_and_b32 v0, 63, v0
    v_readfirstlane_b32 s3, v1
    s_cmp_lg_u32 s3, 1
    s_cbranch_scc1 L_nowarm
    s_getpc_b64 s[38:39]
L_pc0:
    s_bfe_u32 s36, s2, 0x20003
    s_mul_i32 s36, s36, 6144
    v_lshl_add_u32 v20, v0, 7, s36
    v_min_u32 v20, L_codeend-L_pc0-4, v20
    global_load_dword v22, v20, s[38:39]
L_nowarm:
    v_lshrrev_b32 v2, 4, v0
    v_and_b32 v3, 15, v0
    v_mov_b32 v1, 135168
    v_and_b32 v8, 12, v3
    v_cmp_eq_u32 vcc, 4, v8
    v_lshl_add_u32 v10, v3, 2, v1
    v_mov_b32 v9, 0
    v_cndmask_b32 v8, 0, -5, vcc
    ds_write_b32 v10, v8
    v_xor_b32 v4, v3, v2
    v_lshlrev_b32 v4, 4, v4
    v_lshl_add_u32 v4, v2, 8, v4
    v_xor_b32 v5, 64, v4
    v_xor_b32 v6, 128, v4
    v_xor_b32 v7, 192, v4
    s_and_b32 s22, s2, 7
    s_lshr_b32 s23, s2, 4
    s_lshl_b32 s23, s23, 3
    s_or_b32 s22, s22, s23
    s_bfe_u32 s23, s2, 0x10003
    s_lshl_b32 s2, s22, 1
    s_or_b32 s2, s2, s23
    s_mov_b32 s25, 4194304
    s_mov_b32 s39, 0x20000
    s_cmp_eq_u32 s23, 0
    s_cselect_b32 s24, 68, 61
    s_cmp_eq_u32 s3, 0
    s_cbranch_scc1 L_loader
    s_cmp_eq_u32 s3, 1
    s_cbranch_scc1 L_bar1
    s_sub_u32 s3, s3, 2
    s_lshl_b32 s33, s22, 2
    s_add_u32 s33, s33, s3
    s_lshl_b32 s33, s33, 13
    s_add_u32 s35, s33, 4096
    s_lshl_b32 s34, s3, 13
    s_add_u32 s34, s34, 32768
    s_mov_b32 s38, 0x400000
    s_mov_b32 m0, s34
    s_waitcnt lgkmcnt(0)
    s_mov_b32 s36, s4
    s_mov_b32 s37, s5
    buffer_load_dwordx4 v4, s[36:39], s33 offen offset:0  lds
    buffer_load_dwordx4 v5, s[36:39], s33 offen offset:1024  lds
    buffer_load_dwordx4 v6, s[36:39], s33 offen offset:2048  lds
    buffer_load_dwordx4 v7, s[36:39], s33 offen offset:3072  lds
    s_add_u32 m0, s34, 4096
    s_nop 0
    buffer_load_dwordx4 v4, s[36:39], s35 offen offset:0  lds
    buffer_load_dwordx4 v5, s[36:39], s35 offen offset:1024  lds
    buffer_load_dwordx4 v6, s[36:39], s35 offen offset:2048  lds
    buffer_load_dwordx4 v7, s[36:39], s35 offen offset:3072  lds
    s_cmp_lg_u32 s23, 0
    s_cbranch_scc1 L_nomask
    s_mov_b32 s40, s14
    s_mov_b32 s41, s15
    s_mov_b32 s42, 0x8000
    s_mov_b32 s43, 0x20000
    v_lshlrev_b32 v28, 6, v3
    v_lshl_add_u32 v28, v2, 3, v28
    s_lshr_b32 s35, s22, 3
    s_lshl_b32 s35, s35, 11
    buffer_load_dwordx2 v[240:241], v28, s[40:43], s35 offen offset:0
    buffer_load_dwordx2 v[242:243], v28, s[40:43], s35 offen offset:1024
    buffer_load_dwordx2 v[244:245], v28, s[40:43], s35 offen offset:32
    buffer_load_dwordx2 v[246:247], v28, s[40:43], s35 offen offset:1056
L_nomask:
    s_barrier
    s_branch L_consumer
L_bar1:
    s_waitcnt lgkmcnt(0)
    s_barrier
    s_branch L_helper
L_loader:
    s_setprio 3
    s_lshl_b32 s26, s22, 20
    s_mul_i32 s27, s23, 548864
    s_add_u32 s26, s26, s27
    s_mov_b32 s78, s26
    s_cmp_eq_u32 s23, 0
    s_cselect_b32 s79, 67, 61
    s_lshl_b32 s79, s79, 13
    s_add_u32 s79, s79, s78
    s_cmp_eq_u32 s23, 0
    s_cselect_b32 s28, 1, 0
    s_lshr_b32 s27, s22, 3
    s_mul_i32 s27, s27, 0
    s_add_u32 s28, s28, s27
    s_and_b32 s27, s22, 7
    s_mul_i32 s27, s27, 2
    s_add_u32 s27, s27, s28
    s_and_b32 s27, s27, 31
    s_lshl_b32 s27, s27, 13
    s_add_u32 s26, s26, s27
    s_mov_b32 s38, 0x8000000
    s_mov_b32 s30, 0
    s_mov_b32 s32, 0
    s_waitcnt lgkmcnt(0)
    s_mov_b32 s36, s6
    s_mov_b32 s37, s7
    s_mov_b32 m0, s30
    s_add_u32 s34, s26, 4096
    buffer_load_dwordx4 v4, s[36:39], s26 offen offset:0 nt lds
    buffer_load_dwordx4 v5, s[36:39], s26 offen offset:1024 nt lds
    buffer_load_dwordx4 v6, s[36:39], s26 offen offset:2048 nt lds
    buffer_load_dwordx4 v7, s[36:39], s26 offen offset:3072 nt lds
    s_add_u32 m0, s30, 4096
    s_nop 0
    buffer_load_dwordx4 v4, s[36:39], s34 offen offset:0 nt lds
    buffer_load_dwordx4 v5, s[36:39], s34 offen offset:1024 nt lds
    buffer_load_dwordx4 v6, s[36:39], s34 offen offset:2048 nt lds
    buffer_load_dwordx4 v7, s[36:39], s34 offen offset:3072 nt lds
    s_add_u32 s32, s32, 1
    s_add_u32 s30, s30, 8192
    s_barrier
    s_mov_b32 s29, s26
    s_add_u32 s26, s26, 8192
    s_mov_b32 s28, s26
    s_add_u32 s28, s28, 8192
    s_lshl_b32 s27, s22, 13
    s_mov_b32 s47, 0x20000
    s_mov_b32 s51, 0x20000
    s_cmp_eq_u32 s23, 0
    s_cselect_b32 s46, 0x100000, s38
    s_cselect_b32 s50, 0x100000, s38
    s_cselect_b32 s44, s10, s6
    s_cselect_b32 s45, s11, s7
    s_cselect_b32 s48, s12, s8
    s_cselect_b32 s49, s13, s9
    s_cselect_b32 s27, s27, s26
    s_cselect_b32 s28, s26, s28
    s_mov_b32 m0, s30
    s_add_u32 s34, s27, 4096
    buffer_load_dwordx4 v4, s[44:47], s27 offen offset:0 nt lds
    buffer_load_dwordx4 v5, s[44:47], s27 offen offset:1024 nt lds
    buffer_load_dwordx4 v6, s[44:47], s27 offen offset:2048 nt lds
    buffer_load_dwordx4 v7, s[44:47], s27 offen offset:3072 nt lds
    s_add_u32 m0, s30, 4096
    s_nop 0
    buffer_load_dwordx4 v4, s[44:47], s34 offen offset:0 nt lds
    buffer_load_dwordx4 v5, s[44:47], s34 offen offset:1024 nt lds
    buffer_load_dwordx4 v6, s[44:47], s34 offen offset:2048 nt lds
    buffer_load_dwordx4 v7, s[44:47], s34 offen offset:3072 nt lds
    s_add_u32 s32, s32, 1
    s_add_u32 s30, s30, 8192
    v_lshlrev_b32 v17, 1, v2
    v_xor_b32 v17, v3, v17
    v_lshlrev_b32 v17, 4, v17
    v_lshl_add_u32 v17, v2, 8, v17
    v_xor_b32 v18, 128, v17
    s_mov_b32 s40, s8
    s_mov_b32 s41, s9
    s_mov_b32 s42, 0x8000000
    s_mov_b32 s43, 0x20000
    s_mov_b32 s31, 65536
    s_mov_b32 s65, 80
    s_mul_i32 s64, s2, 79
    s_and_b32 s64, s64, 127
    s_or_b32 s64, s64, 256
    s_mov_b32 s26, s28
    s_mov_b32 m0, s31
    s_add_u32 s34, s29, 4096
    buffer_load_dwordx4 v17, s[40:43], s29 offen offset:0 nt lds
    buffer_load_dwordx4 v18, s[40:43], s29 offen offset:1024 nt lds
    buffer_load_dwordx4 v17, s[40:43], s29 offen offset:2048 nt lds
    buffer_load_dwordx4 v18, s[40:43], s29 offen offset:3072 nt lds
    s_add_u32 m0, s31, 4096
    s_nop 0
    buffer_load_dwordx4 v17, s[40:43], s34 offen offset:0 nt lds
    buffer_load_dwordx4 v18, s[40:43], s34 offen offset:1024 nt lds
    buffer_load_dwordx4 v17, s[40:43], s34 offen offset:2048 nt lds
    buffer_load_dwordx4 v18, s[40:43], s34 offen offset:3072 nt lds
    s_waitcnt vmcnt(23)
    s_add_u32 s32, s32, 1
    s_add_u32 s31, s31, 8192
    s_mov_b32 s29, s26
    s_mov_b32 m0, s30
    s_add_u32 s34, s26, 4096
    buffer_load_dwordx4 v4, s[36:39], s26 offen offset:0 nt lds
    s_waitcnt vmcnt(23)
    buffer_load_dwordx4 v5, s[36:39], s26 offen offset:1024 nt lds
    s_waitcnt vmcnt(23)
    buffer_load_dwordx4 v6, s[36:39], s26 offen offset:2048 nt lds
    s_waitcnt vmcnt(23)
    buffer_load_dwordx4 v7, s[36:39], s26 offen offset:3072 nt lds
    s_waitcnt vmcnt(23)
    s_add_u32 m0, s30, 4096
    s_nop 0
    buffer_load_dwordx4 v4, s[36:39], s34 offen offset:0 nt lds
    s_waitcnt vmcnt(23)
    buffer_load_dwordx4 v5, s[36:39], s34 offen offset:1024 nt lds
    s_waitcnt vmcnt(23)
    buffer_load_dwordx4 v6, s[36:39], s34 offen offset:2048 nt lds
    s_waitcnt vmcnt(23)
    s_sub_u32 s68, s32, 2
    v_mov_b32 v8, s68
    ds_write_b32 v1, v8
    buffer_load_dwordx4 v7, s[36:39], s34 offen offset:3072 nt lds
    s_waitcnt vmcnt(23)
    s_add_u32 s32, s32, 1
    s_add_u32 s30, s30, 8192
    s_add_u32 s26, s26, 8192
    s_mov_b32 m0, s31
    s_add_u32 s34, s27, 4096
    buffer_load_dwordx4 v17, s[48:51], s27 offen offset:0 nt lds
    s_waitcnt vmcnt(23)
    buffer_load_dwordx4 v18, s[48:51], s27 offen offset:1024 nt lds
    s_waitcnt vmcnt(23)
    buffer_load_dwordx4 v17, s[48:51], s27 offen offset:2048 nt lds
    s_waitcnt vmcnt(23)
    buffer_load_dwordx4 v18, s[48:51], s27 offen offset:3072 nt lds
    s_waitcnt vmcnt(23)
    s_add_u32 m0, s31, 4096
    s_nop 0
    buffer_load_dwordx4 v17, s[48:51], s34 offen offset:0 nt lds
    s_waitcnt vmcnt(23)
    buffer_load_dwordx4 v18, s[48:51], s34 offen offset:1024 nt lds
    s_waitcnt vmcnt(23)
    buffer_load_dwordx4 v17, s[48:51], s34 offen offset:2048 nt lds
    s_waitcnt vmcnt(23)
    s_sub_u32 s68, s32, 2
    v_mov_b32 v8, s68
    ds_write_b32 v1, v8
    buffer_load_dwordx4 v18, s[48:51], s34 offen offset:3072 nt lds
    s_waitcnt vmcnt(23)
    s_add_u32 s32, s32, 1
    s_add_u32 s31, s31, 8192
    v_and_b32 v11, 3, v0
    v_lshlrev_b32 v12, 2, v11
    v_add_u32 v11, 135184, v12
    s_mov_b32 s56, 2
    v_mov_b32 v13, -4
    s_sub_u32 s57, s24, 1
    s_min_u32 s58, s57, 60
L_unita:
    s_mov_b32 m0, s30
    s_add_u32 s34, s26, 4096
    buffer_load_dwordx4 v4, s[36:39], s26 offen offset:0 nt lds
    s_waitcnt vmcnt(19)
    buffer_load_dwordx4 v5, s[36:39], s26 offen offset:1024 nt lds
    s_waitcnt vmcnt(19)
    buffer_load_dwordx4 v6, s[36:39], s26 offen offset:2048 nt lds
    s_waitcnt vmcnt(19)
    buffer_load_dwordx4 v7, s[36:39], s26 offen offset:3072 nt lds
    s_waitcnt vmcnt(19)
    s_add_u32 m0, s30, 4096
    s_nop 0
    buffer_load_dwordx4 v4, s[36:39], s34 offen offset:0 nt lds
    s_waitcnt vmcnt(19)
    buffer_load_dwordx4 v5, s[36:39], s34 offen offset:1024 nt lds
    s_waitcnt vmcnt(19)
    buffer_load_dwordx4 v6, s[36:39], s34 offen offset:2048 nt lds
    s_add_u32 s26, s26, 8192
    s_add_u32 s30, s30, 8192
    s_and_b32 s30, s30, 0xffff
    s_waitcnt vmcnt(19)
    buffer_load_dwordx4 v7, s[36:39], s34 offen offset:3072 nt lds
    s_cmp_eq_u32 s26, s79
    s_cselect_b32 s26, s78, s26
    s_waitcnt vmcnt(19)
L_unitVa:
    s_mov_b32 m0, s31
    s_add_u32 s34, s29, 4096
    buffer_load_dwordx4 v17, s[40:43], s29 offen offset:0 nt lds
    ds_read_b32 v14, v11
    s_waitcnt vmcnt(19)
    buffer_load_dwordx4 v18, s[40:43], s29 offen offset:1024 nt lds
    s_waitcnt vmcnt(19)
    buffer_load_dwordx4 v17, s[40:43], s29 offen offset:2048 nt lds
    s_waitcnt lgkmcnt(0)
    s_lshl_b32 s68, s56, 1
    s_add_u32 s68, s68, 0
    s_cmp_gt_i32 s68, 4
    s_cselect_b32 s66, s65, 0
    s_cselect_b32 s67, 4, 0
    s_add_u32 s64, s64, s66
    s_add_u32 s65, s65, s67
    s_min_u32 s65, s65, 132
    v_readfirstlane_b32 s69, v14
    s_max_i32 s69, s69, 0
    s_lshl_b32 s69, s69, 7
    s_add_u32 s69, s69, 512
    s_cmp_lt_u32 s56, 15
    s_cselect_b32 s69, s69, s64
    s_cmp_gt_i32 s64, s69
    s_cselect_b32 s69, 128, 0
    s_sub_u32 s64, s64, s69
    s_lshl_b32 s67, s56, 7
    s_sub_u32 s67, s67, 512
    s_cmp_lt_i32 s64, s67
    s_cselect_b32 s67, 128, 0
    s_add_u32 s64, s64, s67
    s_lshr_b32 s66, s64, 6
    s_min_i32 s68, s66, s68
    v_mov_b32 v8, s68
    s_waitcnt vmcnt(19)
    buffer_load_dwordx4 v18, s[40:43], s29 offen offset:3072 nt lds
    ds_write_b32 v1, v8
    s_waitcnt vmcnt(19)
    s_add_u32 m0, s31, 4096
    s_nop 0
    buffer_load_dwordx4 v17, s[40:43], s34 offen offset:0 nt lds
    s_waitcnt vmcnt(19)
    buffer_load_dwordx4 v18, s[40:43], s34 offen offset:1024 nt lds
    ds_read_b32 v14, v11
    s_waitcnt vmcnt(19)
    buffer_load_dwordx4 v17, s[40:43], s34 offen offset:2048 nt lds
    s_add_u32 s29, s29, 8192
    s_add_u32 s31, s31, 8192
    s_and_b32 s31, s31, 0xffff
    s_bitset1_b32 s31, 16
    s_add_u32 s56, s56, 1
    s_waitcnt vmcnt(19)
    buffer_load_dwordx4 v18, s[40:43], s34 offen offset:3072 nt lds
    s_cmp_eq_u32 s29, s79
    s_cselect_b32 s29, s78, s29
    s_waitcnt lgkmcnt(0)
    v_cmp_lt_i32 vcc, v14, v13
    v_add_u32 v13, 1, v13
    s_cbranch_vccnz L_lpa
L_lpoka:
    s_cmp_lt_u32 s56, 30
    s_waitcnt vmcnt(19)
    s_cbranch_scc1 L_unita
L_unitb:
    s_mov_b32 m0, s30
    s_add_u32 s34, s26, 4096
    buffer_load_dwordx4 v4, s[36:39], s26 offen offset:0 nt lds
    s_waitcnt vmcnt(18)
    buffer_load_dwordx4 v5, s[36:39], s26 offen offset:1024 nt lds
    s_waitcnt vmcnt(18)
    buffer_load_dwordx4 v6, s[36:39], s26 offen offset:2048 nt lds
    s_waitcnt vmcnt(18)
    buffer_load_dwordx4 v7, s[36:39], s26 offen offset:3072 nt lds
    s_waitcnt vmcnt(18)
    s_add_u32 m0, s30, 4096
    s_nop 0
    buffer_load_dwordx4 v4, s[36:39], s34 offen offset:0 nt lds
    s_waitcnt vmcnt(18)
    buffer_load_dwordx4 v5, s[36:39], s34 offen offset:1024 nt lds
    s_waitcnt vmcnt(18)
    buffer_load_dwordx4 v6, s[36:39], s34 offen offset:2048 nt lds
    s_add_u32 s26, s26, 8192
    s_add_u32 s30, s30, 8192
    s_and_b32 s30, s30, 0xffff
    s_waitcnt vmcnt(18)
    buffer_load_dwordx4 v7, s[36:39], s34 offen offset:3072 nt lds
    s_cmp_eq_u32 s26, s79
    s_cselect_b32 s26, s78, s26
    s_waitcnt vmcnt(18)
L_unitVb:
    s_mov_b32 m0, s31
    s_add_u32 s34, s29, 4096
    buffer_load_dwordx4 v17, s[40:43], s29 offen offset:0 nt lds
    s_waitcnt vmcnt(18)
    buffer_load_dwordx4 v18, s[40:43], s29 offen offset:1024 nt lds
    s_lshl_b32 s68, s56, 1
    s_add_u32 s68, s68, 0
    s_cmp_gt_i32 s68, 4
    s_cselect_b32 s66, s65, 0
    s_cselect_b32 s67, 4, 0
    s_add_u32 s64, s64, s66
    s_add_u32 s65, s65, s67
    s_min_u32 s65, s65, 132
    s_lshl_b32 s67, s56, 7
    s_sub_u32 s67, s67, 512
    s_cmp_lt_i32 s64, s67
    s_cselect_b32 s67, 128, 0
    s_add_u32 s64, s64, s67
    s_lshr_b32 s66, s64, 6
    s_min_i32 s68, s66, s68
    v_mov_b32 v8, s68
    s_waitcnt vmcnt(18)
    buffer_load_dwordx4 v17, s[40:43], s29 offen offset:2048 nt lds
    ds_write_b32 v1, v8
    s_waitcnt vmcnt(18)
    buffer_load_dwordx4 v18, s[40:43], s29 offen offset:3072 nt lds
    s_waitcnt vmcnt(18)
    s_add_u32 m0, s31, 4096
    s_nop 0
    buffer_load_dwordx4 v17, s[40:43], s34 offen offset:0 nt lds
    s_waitcnt vmcnt(18)
    buffer_load_dwordx4 v18, s[40:43], s34 offen offset:1024 nt lds
    ds_read_b32 v14, v11
    s_waitcnt vmcnt(18)
    buffer_load_dwordx4 v17, s[40:43], s34 offen offset:2048 nt lds
    s_add_u32 s29, s29, 8192
    s_add_u32 s31, s31, 8192
    s_and_b32 s31, s31, 0xffff
    s_bitset1_b32 s31, 16
    s_add_u32 s56, s56, 1
    s_waitcnt vmcnt(18)
    buffer_load_dwordx4 v18, s[40:43], s34 offen offset:3072 nt lds
    s_cmp_eq_u32 s29, s79
    s_cselect_b32 s29, s78, s29
    s_waitcnt lgkmcnt(0)
    v_cmp_lt_i32 vcc, v14, v13
    v_add_u32 v13, 1, v13
    s_cbranch_vccnz L_lpb
L_lpokb:
    s_cmp_lt_u32 s56, s58
    s_waitcnt vmcnt(18)
    s_cbranch_scc1 L_unitb
    s_cmp_lt_u32 s56, s57
    s_cbranch_scc0 L_unitVc
L_unitc:
    s_mov_b32 m0, s30
    s_add_u32 s34, s26, 4096
    buffer_load_dwordx4 v4, s[36:39], s26 offen offset:0 nt lds
    s_waitcnt vmcnt(31)
    buffer_load_dwordx4 v5, s[36:39], s26 offen offset:1024 nt lds
    s_waitcnt vmcnt(31)
    buffer_load_dwordx4 v6, s[36:39], s26 offen offset:2048 nt lds
    s_waitcnt vmcnt(31)
    buffer_load_dwordx4 v7, s[36:39], s26 offen offset:3072 nt lds
    s_waitcnt vmcnt(31)
    s_add_u32 m0, s30, 4096
    s_nop 0
    buffer_load_dwordx4 v4, s[36:39], s34 offen offset:0 nt lds
    s_waitcnt vmcnt(31)
    buffer_load_dwordx4 v5, s[36:39], s34 offen offset:1024 nt lds
    s_waitcnt vmcnt(31)
    buffer_load_dwordx4 v6, s[36:39], s34 offen offset:2048 nt lds
    s_lshl_b32 s68, s56, 1
    s_add_u32 s68, s68, -2
    v_mov_b32 v8, s68
    s_add_u32 s26, s26, 8192
    s_add_u32 s30, s30, 8192
    s_and_b32 s30, s30, 0xffff
    s_waitcnt vmcnt(31)
    buffer_load_dwordx4 v7, s[36:39], s34 offen offset:3072 nt lds
    ds_write_b32 v1, v8
    s_cmp_eq_u32 s26, s79
    s_cselect_b32 s26, s78, s26
    s_waitcnt vmcnt(31)
L_unitVc:
    s_mov_b32 m0, s31
    s_add_u32 s34, s29, 4096
    buffer_load_dwordx4 v17, s[40:43], s29 offen offset:0 nt lds
    s_waitcnt vmcnt(31)
    buffer_load_dwordx4 v18, s[40:43], s29 offen offset:1024 nt lds
    s_waitcnt vmcnt(31)
    buffer_load_dwordx4 v17, s[40:43], s29 offen offset:2048 nt lds
    s_waitcnt vmcnt(31)
    buffer_load_dwordx4 v18, s[40:43], s29 offen offset:3072 nt lds
    s_waitcnt vmcnt(31)
    s_add_u32 m0, s31, 4096
    s_nop 0
    buffer_load_dwordx4 v17, s[40:43], s34 offen offset:0 nt lds
    s_waitcnt vmcnt(31)
    buffer_load_dwordx4 v18, s[40:43], s34 offen offset:1024 nt lds
    ds_read_b32 v14, v11
    s_waitcnt vmcnt(31)
    buffer_load_dwordx4 v17, s[40:43], s34 offen offset:2048 nt lds
    s_add_u32 s29, s29, 8192
    s_add_u32 s31, s31, 8192
    s_and_b32 s31, s31, 0xffff
    s_bitset1_b32 s31, 16
    s_add_u32 s56, s56, 1
    s_waitcnt vmcnt(31)
    buffer_load_dwordx4 v18, s[40:43], s34 offen offset:3072 nt lds
    s_cmp_eq_u32 s29, s79
    s_cselect_b32 s29, s78, s29
    s_waitcnt lgkmcnt(0)
    v_cmp_lt_i32 vcc, v14, v13
    v_add_u32 v13, 1, v13
    s_cbranch_vccnz L_lpc
L_lpokc:
    s_cmp_lt_u32 s56, s57
    s_waitcnt vmcnt(31)
    s_cbranch_scc1 L_unitc
    s_cmp_eq_u32 s56, s57
    s_cbranch_scc1 L_unitVc
    s_lshl_b32 s32, s24, 1
    s_sub_u32 s68, s32, 4
    v_mov_b32 v8, s68
    s_waitcnt vmcnt(32)
    ds_write_b32 v1, v8
    s_sub_u32 s68, s32, 2
    v_mov_b32 v8, s68
    s_waitcnt vmcnt(16)
    ds_write_b32 v1, v8
    s_sub_u32 s68, s32, 0
    v_mov_b32 v8, s68
    s_waitcnt vmcnt(8)
    ds_write_b32 v1, v8
    s_add_u32 s68, s32, 2
    v_mov_b32 v8, s68
    s_waitcnt vmcnt(0)
    ds_write_b32 v1, v8
    s_waitcnt lgkmcnt(0)
L_end0:
    s_endpgm
L_lpa:
    v_subrev_u32 v15, 1, v13
L_lqa:
    s_sleep 1
    ds_read_b32 v14, v11
    s_sub_u32 s25, s25, 1
    s_cbranch_scc1 L_end0
    s_waitcnt lgkmcnt(0)
    v_cmp_lt_i32 vcc, v14, v15
    s_cbranch_vccnz L_lqa
    s_branch L_lpoka
L_lpb:
    v_subrev_u32 v15, 1, v13
L_lqb:
    s_sleep 1
    ds_read_b32 v14, v11
    s_sub_u32 s25, s25, 1
    s_cbranch_scc1 L_end0
    s_waitcnt lgkmcnt(0)
    v_cmp_lt_i32 vcc, v14, v15
    s_cbranch_vccnz L_lqb
    s_branch L_lpokb
L_lpc:
    v_subrev_u32 v15, 1, v13
L_lqc:
    s_sleep 1
    ds_read_b32 v14, v11
    s_sub_u32 s25, s25, 1
    s_cbranch_scc1 L_end0
    s_waitcnt lgkmcnt(0)
    v_cmp_lt_i32 vcc, v14, v15
    s_cbranch_vccnz L_lqc
    s_branch L_lpokc
L_helper:
    v_and_b32 v11, 3, v0
    v_lshlrev_b32 v12, 2, v11
    v_add_u32 v11, 135184, v12
    s_lshl_b32 s35, s22, 7
    s_add_u32 s35, s35, 33554432
    s_mov_b32 s52, s20
    s_mov_b32 s53, s21
    s_mov_b32 s54, 0x4000000
    s_mov_b32 s55, 0x20000
    s_mov_b32 s33, -5
    s_cmp_lg_u32 s2, 0
    s_cbranch_scc1 L_hrecv
    s_mov_b32 s40, 33570816
    s_mov_b64 exec, 1
    buffer_load_dwordx2 v[16:17], v9, s[52:55], s40 offen sc1
    s_waitcnt vmcnt(0)
    v_or_b32 v16, 1, v16
    v_add_co_u32 v16, vcc, 2, v16
    s_nop 1
    v_addc_co_u32 v17, vcc, 0, v17, vcc
    buffer_store_dwordx2 v[16:17], v9, s[52:55], s40 offen sc1
    global_store_dwordx2 v9, v[16:17], s[18:19] sc1
    s_mov_b64 exec, -1
L_hrecv:
    s_mov_b32 s57, 47
    s_cmp_ge_i32 s33, s57
    s_cbranch_scc1 L_spaceg
    v_mov_b32 v13, s57
L_spollg:
    ds_read_b32 v14, v11
    s_sub_u32 s25, s25, 1
    s_cbranch_scc1 L_end2
    s_waitcnt lgkmcnt(0)
    v_cmp_lt_i32 vcc, v14, v13
    s_cbranch_vccz L_sokg
    s_sleep 4
    s_branch L_spollg
L_sokg:
    v_readlane_b32 s33, v14, 0
    v_readlane_b32 s58, v14, 1
    v_readlane_b32 s59, v14, 2
    v_readlane_b32 s60, v14, 3
    s_min_i32 s33, s33, s58
    s_min_i32 s59, s59, s60
    s_min_i32 s33, s33, s59
L_spaceg:
L_hst:
    global_load_dwordx2 v[16:17], v9, s[18:19] sc1
    s_sub_u32 s25, s25, 64
    s_cbranch_scc1 L_end2
    s_waitcnt vmcnt(0)
    v_readfirstlane_b32 s37, v16
    s_cmp_lg_u32 s37, 0
    s_cbranch_scc1 L_hst_ok
    s_sleep 4
    s_branch L_hst
L_hst_ok:
    ds_write_b64 v1, v[16:17] offset:32
    s_waitcnt lgkmcnt(0)
    s_cmp_eq_u32 s23, 1
    s_cbranch_scc1 L_end2
    s_sub_u32 s57, s24, 5
    s_cmp_ge_i32 s33, s57
    s_cbranch_scc1 L_spaceh
    v_mov_b32 v13, s57
L_spollh:
    ds_read_b32 v14, v11
    s_sub_u32 s25, s25, 1
    s_cbranch_scc1 L_end2
    s_waitcnt lgkmcnt(0)
    v_cmp_lt_i32 vcc, v14, v13
    s_cbranch_vccz L_sokh
    s_sleep 1
    s_branch L_spollh
L_sokh:
    v_readlane_b32 s33, v14, 0
    v_readlane_b32 s58, v14, 1
    v_readlane_b32 s59, v14, 2
    v_readlane_b32 s60, v14, 3
    s_min_i32 s33, s33, s58
    s_min_i32 s59, s59, s60
    s_min_i32 s33, s33, s59
L_spaceh:
    v_lshlrev_b32 v12, 1, v12
L_fpoll:
    buffer_load_dwordx2 v[14:15], v12, s[52:55], s35 offen sc1
    s_sub_u32 s25, s25, 64
    s_cbranch_scc1 L_end2
    s_waitcnt vmcnt(0)
    v_cmp_ne_u64 vcc, v[14:15], v[16:17]
    s_cbranch_vccz L_fok
    s_sleep 1
    s_branch L_fpoll
L_fok:
    v_lshlrev_b32 v3, 4, v0
    s_mul_i32 s35, s22, 36864
    s_add_u32 s35, s35, 1048576
    s_mov_b32 m0, 131072
    s_add_u32 s34, s35, 32768
    buffer_load_dwordx4 v3, s[52:55], s34 offen offset:0 sc1 lds
    buffer_load_dwordx4 v3, s[52:55], s34 offen offset:1024 sc1 lds
    buffer_load_dwordx4 v3, s[52:55], s34 offen offset:2048 sc1 lds
    buffer_load_dwordx4 v3, s[52:55], s34 offen offset:3072 sc1 lds
    s_and_b32 s30, s24, 7
    s_lshl_b32 s30, s30, 13
    s_add_u32 m0, s30, 0
    s_nop 0
    buffer_load_dwordx4 v3, s[52:55], s35 offen offset:0 sc1 lds
    buffer_load_dwordx4 v3, s[52:55], s35 offen offset:1024 sc1 lds
    buffer_load_dwordx4 v3, s[52:55], s35 offen offset:2048 sc1 lds
    buffer_load_dwordx4 v3, s[52:55], s35 offen offset:3072 sc1 lds
    s_add_u32 s35, s35, 4096
    s_add_u32 m0, s30, 4096
    s_nop 0
    buffer_load_dwordx4 v3, s[52:55], s35 offen offset:0 sc1 lds
    buffer_load_dwordx4 v3, s[52:55], s35 offen offset:1024 sc1 lds
    buffer_load_dwordx4 v3, s[52:55], s35 offen offset:2048 sc1 lds
    buffer_load_dwordx4 v3, s[52:55], s35 offen offset:3072 sc1 lds
    s_add_u32 s35, s35, 4096
    s_add_u32 s30, s30, 8192
    s_and_b32 s30, s30, 0xffff
    s_add_u32 m0, s30, 0
    s_nop 0
    buffer_load_dwordx4 v3, s[52:55], s35 offen offset:0 sc1 lds
    buffer_load_dwordx4 v3, s[52:55], s35 offen offset:1024 sc1 lds
    buffer_load_dwordx4 v3, s[52:55], s35 offen offset:2048 sc1 lds
    buffer_load_dwordx4 v3, s[52:55], s35 offen offset:3072 sc1 lds
    s_add_u32 s35, s35, 4096
    s_add_u32 m0, s30, 4096
    s_nop 0
    buffer_load_dwordx4 v3, s[52:55], s35 offen offset:0 sc1 lds
    buffer_load_dwordx4 v3, s[52:55], s35 offen offset:1024 sc1 lds
    buffer_load_dwordx4 v3, s[52:55], s35 offen offset:2048 sc1 lds
    buffer_load_dwordx4 v3, s[52:55], s35 offen offset:3072 sc1 lds
    s_add_u32 s35, s35, 4096
    s_add_u32 s30, s30, 8192
    s_and_b32 s30, s30, 0xffff
    s_add_u32 m0, s30, 0
    s_nop 0
    buffer_load_dwordx4 v3, s[52:55], s35 offen offset:0 sc1 lds
    buffer_load_dwordx4 v3, s[52:55], s35 offen offset:1024 sc1 lds
    buffer_load_dwordx4 v3, s[52:55], s35 offen offset:2048 sc1 lds
    buffer_load_dwordx4 v3, s[52:55], s35 offen offset:3072 sc1 lds
    s_add_u32 s35, s35, 4096
    s_add_u32 m0, s30, 4096
    s_nop 0
    buffer_load_dwordx4 v3, s[52:55], s35 offen offset:0 sc1 lds
    buffer_load_dwordx4 v3, s[52:55], s35 offen offset:1024 sc1 lds
    buffer_load_dwordx4 v3, s[52:55], s35 offen offset:2048 sc1 lds
    buffer_load_dwordx4 v3, s[52:55], s35 offen offset:3072 sc1 lds
    s_add_u32 s35, s35, 4096
    s_add_u32 s30, s30, 8192
    s_and_b32 s30, s30, 0xffff
    s_add_u32 m0, s30, 0
    s_nop 0
    buffer_load_dwordx4 v3, s[52:55], s35 offen offset:0 sc1 lds
    buffer_load_dwordx4 v3, s[52:55], s35 offen offset:1024 sc1 lds
    buffer_load_dwordx4 v3, s[52:55], s35 offen offset:2048 sc1 lds
    buffer_load_dwordx4 v3, s[52:55], s35 offen offset:3072 sc1 lds
    s_add_u32 s35, s35, 4096
    s_add_u32 m0, s30, 4096
    s_nop 0
    buffer_load_dwordx4 v3, s[52:55], s35 offen offset:0 sc1 lds
    buffer_load_dwordx4 v3, s[52:55], s35 offen offset:1024 sc1 lds
    buffer_load_dwordx4 v3, s[52:55], s35 offen offset:2048 sc1 lds
    buffer_load_dwordx4 v3, s[52:55], s35 offen offset:3072 sc1 lds
    s_add_u32 s35, s35, 4096
    s_add_u32 s30, s30, 8192
    s_and_b32 s30, s30, 0xffff
    v_mov_b32 v8, 1
    s_waitcnt vmcnt(24)
    ds_write_b32 v1, v8 offset:4
    v_mov_b32 v8, 2
    s_waitcnt vmcnt(16)
    ds_write_b32 v1, v8 offset:4
    v_mov_b32 v8, 3
    s_waitcnt vmcnt(8)
    ds_write_b32 v1, v8 offset:4
    v_mov_b32 v8, 4
    s_waitcnt vmcnt(0)
    ds_write_b32 v1, v8 offset:4
    s_waitcnt lgkmcnt(0)
L_end2:
    s_endpgm
L_consumer:
    v_xor_b32 v29, v2, v3
    v_lshlrev_b32 v30, 8, v3
    v_lshl_add_u32 v12, v29, 4, v30
    v_xor_b32 v13, 64, v12
    v_xor_b32 v14, 128, v12
    v_xor_b32 v15, 192, v12
    v_lshrrev_b32 v29, 2, v0
    v_lshlrev_b32 v30, 8, v29
    v_and_b32 v29, 7, v29
    v_lshl_add_u32 v30, v29, 5, v30
    v_and_b32 v29, 3, v0
    v_lshl_add_u32 v30, v29, 3, v30
    v_add_u32 v16, 65536, v30
    v_xor_b32 v17, 32, v16
    v_xor_b32 v18, 64, v16
    v_xor_b32 v19, 96, v16
    v_xor_b32 v20, 128, v16
    v_xor_b32 v21, 160, v16
    v_xor_b32 v22, 192, v16
    v_xor_b32 v23, 224, v16
    v_add_u32 v224, s34, v12
    v_add_u32 v225, s34, v13
    v_add_u32 v226, s34, v14
    v_add_u32 v227, s34, v15
    s_lshl_b32 s35, s3, 2
    s_add_u32 s35, s35, 135184
    v_mov_b32 v8, s35
    v_mov_b32 v9, 0
    s_mov_b32 s26, 0x3e0293ee
    s_mov_b32 s27, 0x44800000
    s_mov_b32 s28, 0
    s_mov_b32 s31, 0xff800000
    v_mov_b32 v4, 0
    v_mov_b32 v5, 0
    v_mov_b32 v2, 0x7f800000
    v_mov_b32 v6, 0
    v_mov_b32 v7, 0
    v_mov_b32 v3, 0x7f800000
    v_mov_b32 v64, 0
    v_mov_b32 v65, 0
    v_mov_b32 v66, 0
    v_mov_b32 v67, 0
    v_mov_b32 v68, 0
    v_mov_b32 v69, 0
    v_mov_b32 v70, 0
    v_mov_b32 v71, 0
    v_mov_b32 v72, 0
    v_mov_b32 v73, 0
    v_mov_b32 v74, 0
    v_mov_b32 v75, 0
    v_mov_b32 v76, 0
    v_mov_b32 v77, 0
    v_mov_b32 v78, 0
    v_mov_b32 v79, 0
    v_mov_b32 v80, 0
    v_mov_b32 v81, 0
    v_mov_b32 v82, 0
    v_mov_b32 v83, 0
    v_mov_b32 v84, 0
    v_mov_b32 v85, 0
    v_mov_b32 v86, 0
    v_mov_b32 v87, 0
    v_mov_b32 v88, 0
    v_mov_b32 v89, 0
    v_mov_b32 v90, 0
    v_mov_b32 v91, 0
    v_mov_b32 v92, 0
    v_mov_b32 v93, 0
    v_mov_b32 v94, 0
    v_mov_b32 v95, 0
    v_mov_b32 v96, 0
    v_mov_b32 v97, 0
    v_mov_b32 v98, 0
    v_mov_b32 v99, 0
    v_mov_b32 v100, 0
    v_mov_b32 v101, 0
    v_mov_b32 v102, 0
    v_mov_b32 v103, 0
    v_mov_b32 v104, 0
    v_mov_b32 v105, 0
    v_mov_b32 v106, 0
    v_mov_b32 v107, 0
    v_mov_b32 v108, 0
    v_mov_b32 v109, 0
    v_mov_b32 v110, 0
    v_mov_b32 v111, 0
    v_mov_b32 v112, 0
    v_mov_b32 v113, 0
    v_mov_b32 v114, 0
    v_mov_b32 v115, 0
    v_mov_b32 v116, 0
    v_mov_b32 v117, 0
    v_mov_b32 v118, 0
    v_mov_b32 v119, 0
    v_mov_b32 v120, 0
    v_mov_b32 v121, 0
    v_mov_b32 v122, 0
    v_mov_b32 v123, 0
    v_mov_b32 v124, 0
    v_mov_b32 v125, 0
    v_mov_b32 v126, 0
    v_mov_b32 v127, 0
    s_lshl_b32 s32, s24, 1
    s_add_u32 s32, s32, 4
    v_mov_b32 v24, 0
    v_mov_b32 v25, 0
    v_mov_b32 v26, 0
    v_mov_b32 v27, 0
    v_mov_b32 v28, 0
    v_mov_b32 v29, 0
    v_mov_b32 v30, 0
    v_mov_b32 v31, 0
    v_mov_b32 v248, 0
    v_mov_b32 v249, 0
    v_mov_b32 v250, 0
    v_mov_b32 v251, 0
    v_mov_b32 v252, 0
    v_mov_b32 v253, 0
    v_mov_b32 v254, 0
    v_mov_b32 v255, 0
    s_waitcnt vmcnt(0)
    ds_read_b128 v[32:35], v224 offset:0
    ds_read_b128 v[36:39], v225 offset:0
    ds_read_b128 v[40:43], v226 offset:0
    ds_read_b128 v[44:47], v227 offset:0
    ds_read_b128 v[48:51], v224 offset:4096
    ds_read_b128 v[52:55], v225 offset:4096
    ds_read_b128 v[56:59], v226 offset:4096
    ds_read_b128 v[60:63], v227 offset:4096
    s_cmp_lg_u32 s23, 0
    s_cbranch_scc1 L_nomask2
    s_mov_b32 s35, 0xceabfb8f
    v_lshlrev_b32 v24, 16, v240
    v_fma_f32 v24, v24, -s35, s35
    v_and_b32 v25, 0xffff0000, v240
    v_fma_f32 v25, v25, -s35, s35
    v_lshlrev_b32 v26, 16, v241
    v_fma_f32 v26, v26, -s35, s35
    v_and_b32 v27, 0xffff0000, v241
    v_fma_f32 v27, v27, -s35, s35
    v_lshlrev_b32 v28, 16, v242
    v_fma_f32 v28, v28, -s35, s35
    v_and_b32 v29, 0xffff0000, v242
    v_fma_f32 v29, v29, -s35, s35
    v_lshlrev_b32 v30, 16, v243
    v_fma_f32 v30, v30, -s35, s35
    v_and_b32 v31, 0xffff0000, v243
    v_fma_f32 v31, v31, -s35, s35
    v_lshlrev_b32 v248, 16, v244
    v_fma_f32 v248, v248, -s35, s35
    v_and_b32 v249, 0xffff0000, v244
    v_fma_f32 v249, v249, -s35, s35
    v_lshlrev_b32 v250, 16, v245
    v_fma_f32 v250, v250, -s35, s35
    v_and_b32 v251, 0xffff0000, v245
    v_fma_f32 v251, v251, -s35, s35
    v_lshlrev_b32 v252, 16, v246
    v_fma_f32 v252, v252, -s35, s35
    v_and_b32 v253, 0xffff0000, v246
    v_fma_f32 v253, v253, -s35, s35
    v_lshlrev_b32 v254, 16, v247
    v_fma_f32 v254, v254, -s35, s35
    v_and_b32 v255, 0xffff0000, v247
    v_fma_f32 v255, v255, -s35, s35
L_nomask2:
    s_waitcnt lgkmcnt(0)
    ds_write_b32 v8, v9
    v_lshlrev_b32 v240, 16, v32
    v_and_b32 v241, 0xffff0000, v32
    v_mul_f32 v240, s26, v240
    v_mul_f32 v241, s26, v241
    v_cvt_pk_bf16_f32 v32, v240, v241
    v_lshlrev_b32 v242, 16, v33
    v_and_b32 v243, 0xffff0000, v33
    v_mul_f32 v242, s26, v242
    v_mul_f32 v243, s26, v243
    v_cvt_pk_bf16_f32 v33, v242, v243
    v_lshlrev_b32 v244, 16, v34
    v_and_b32 v245, 0xffff0000, v34
    v_mul_f32 v244, s26, v244
    v_mul_f32 v245, s26, v245
    v_cvt_pk_bf16_f32 v34, v244, v245
    v_lshlrev_b32 v246, 16, v35
    v_and_b32 v247, 0xffff0000, v35
    v_mul_f32 v246, s26, v246
    v_mul_f32 v247, s26, v247
    v_cvt_pk_bf16_f32 v35, v246, v247
    v_lshlrev_b32 v240, 16, v36
    v_and_b32 v241, 0xffff0000, v36
    v_mul_f32 v240, s26, v240
    v_mul_f32 v241, s26, v241
    v_cvt_pk_bf16_f32 v36, v240, v241
    v_lshlrev_b32 v242, 16, v37
    v_and_b32 v243, 0xffff0000, v37
    v_mul_f32 v242, s26, v242
    v_mul_f32 v243, s26, v243
    v_cvt_pk_bf16_f32 v37, v242, v243
    v_lshlrev_b32 v244, 16, v38
    v_and_b32 v245, 0xffff0000, v38
    v_mul_f32 v244, s26, v244
    v_mul_f32 v245, s26, v245
    v_cvt_pk_bf16_f32 v38, v244, v245
    v_lshlrev_b32 v246, 16, v39
    v_and_b32 v247, 0xffff0000, v39
    v_mul_f32 v246, s26, v246
    v_mul_f32 v247, s26, v247
    v_cvt_pk_bf16_f32 v39, v246, v247
    v_lshlrev_b32 v240, 16, v40
    v_and_b32 v241, 0xffff0000, v40
    v_mul_f32 v240, s26, v240
    v_mul_f32 v241, s26, v241
    v_cvt_pk_bf16_f32 v40, v240, v241
    v_lshlrev_b32 v242, 16, v41
    v_and_b32 v243, 0xffff0000, v41
    v_mul_f32 v242, s26, v242
    v_mul_f32 v243, s26, v243
    v_cvt_pk_bf16_f32 v41, v242, v243
    v_lshlrev_b32 v244, 16, v42
    v_and_b32 v245, 0xffff0000, v42
    v_mul_f32 v244, s26, v244
    v_mul_f32 v245, s26, v245
    v_cvt_pk_bf16_f32 v42, v244, v245
    v_lshlrev_b32 v246, 16, v43
    v_and_b32 v247, 0xffff0000, v43
    v_mul_f32 v246, s26, v246
    v_mul_f32 v247, s26, v247
    v_cvt_pk_bf16_f32 v43, v246, v247
    v_lshlrev_b32 v240, 16, v44
    v_and_b32 v241, 0xffff0000, v44
    v_mul_f32 v240, s26, v240
    v_mul_f32 v241, s26, v241
    v_cvt_pk_bf16_f32 v44, v240, v241
    v_lshlrev_b32 v242, 16, v45
    v_and_b32 v243, 0xffff0000, v45
    v_mul_f32 v242, s26, v242
    v_mul_f32 v243, s26, v243
    v_cvt_pk_bf16_f32 v45, v242, v243
    v_lshlrev_b32 v244, 16, v46
    v_and_b32 v245, 0xffff0000, v46
    v_mul_f32 v244, s26, v244
    v_mul_f32 v245, s26, v245
    v_cvt_pk_bf16_f32 v46, v244, v245
    v_lshlrev_b32 v246, 16, v47
    v_and_b32 v247, 0xffff0000, v47
    v_mul_f32 v246, s26, v246
    v_mul_f32 v247, s26, v247
    v_cvt_pk_bf16_f32 v47, v246, v247
    v_lshlrev_b32 v240, 16, v48
    v_and_b32 v241, 0xffff0000, v48
    v_mul_f32 v240, s26, v240
    v_mul_f32 v241, s26, v241
    v_cvt_pk_bf16_f32 v48, v240, v241
    v_lshlrev_b32 v242, 16, v49
    v_and_b32 v243, 0xffff0000, v49
    v_mul_f32 v242, s26, v242
    v_mul_f32 v243, s26, v243
    v_cvt_pk_bf16_f32 v49, v242, v243
    v_lshlrev_b32 v244, 16, v50
    v_and_b32 v245, 0xffff0000, v50
    v_mul_f32 v244, s26, v244
    v_mul_f32 v245, s26, v245
    v_cvt_pk_bf16_f32 v50, v244, v245
    v_lshlrev_b32 v246, 16, v51
    v_and_b32 v247, 0xffff0000, v51
    v_mul_f32 v246, s26, v246
    v_mul_f32 v247, s26, v247
    v_cvt_pk_bf16_f32 v51, v246, v247
    v_lshlrev_b32 v240, 16, v52
    v_and_b32 v241, 0xffff0000, v52
    v_mul_f32 v240, s26, v240
    v_mul_f32 v241, s26, v241
    v_cvt_pk_bf16_f32 v52, v240, v241
    v_lshlrev_b32 v242, 16, v53
    v_and_b32 v243, 0xffff0000, v53
    v_mul_f32 v242, s26, v242
    v_mul_f32 v243, s26, v243
    v_cvt_pk_bf16_f32 v53, v242, v243
    v_lshlrev_b32 v244, 16, v54
    v_and_b32 v245, 0xffff0000, v54
    v_mul_f32 v244, s26, v244
    v_mul_f32 v245, s26, v245
    v_cvt_pk_bf16_f32 v54, v244, v245
    v_lshlrev_b32 v246, 16, v55
    v_and_b32 v247, 0xffff0000, v55
    v_mul_f32 v246, s26, v246
    v_mul_f32 v247, s26, v247
    v_cvt_pk_bf16_f32 v55, v246, v247
    v_lshlrev_b32 v240, 16, v56
    v_and_b32 v241, 0xffff0000, v56
    v_mul_f32 v240, s26, v240
    v_mul_f32 v241, s26, v241
    v_cvt_pk_bf16_f32 v56, v240, v241
    v_lshlrev_b32 v242, 16, v57
    v_and_b32 v243, 0xffff0000, v57
    v_mul_f32 v242, s26, v242
    v_mul_f32 v243, s26, v243
    v_cvt_pk_bf16_f32 v57, v242, v243
    v_lshlrev_b32 v244, 16, v58
    v_and_b32 v245, 0xffff0000, v58
    v_mul_f32 v244, s26, v244
    v_mul_f32 v245, s26, v245
    v_cvt_pk_bf16_f32 v58, v244, v245
    v_lshlrev_b32 v246, 16, v59
    v_and_b32 v247, 0xffff0000, v59
    v_mul_f32 v246, s26, v246
    v_mul_f32 v247, s26, v247
    v_cvt_pk_bf16_f32 v59, v246, v247
    v_lshlrev_b32 v240, 16, v60
    v_and_b32 v241, 0xffff0000, v60
    v_mul_f32 v240, s26, v240
    v_mul_f32 v241, s26, v241
    v_cvt_pk_bf16_f32 v60, v240, v241
    v_lshlrev_b32 v242, 16, v61
    v_and_b32 v243, 0xffff0000, v61
    v_mul_f32 v242, s26, v242
    v_mul_f32 v243, s26, v243
    v_cvt_pk_bf16_f32 v61, v242, v243
    v_lshlrev_b32 v244, 16, v62
    v_and_b32 v245, 0xffff0000, v62
    v_mul_f32 v244, s26, v244
    v_mul_f32 v245, s26, v245
    v_cvt_pk_bf16_f32 v62, v244, v245
    v_lshlrev_b32 v246, 16, v63
    v_and_b32 v247, 0xffff0000, v63
    v_mul_f32 v246, s26, v246
    v_mul_f32 v247, s26, v247
    v_cvt_pk_bf16_f32 v63, v246, v247
L_ipa:
    ds_read_b32 v10, v1
    s_sub_u32 s25, s25, 1
    s_cbranch_scc1 L_end1
    s_waitcnt lgkmcnt(0)
    v_readfirstlane_b32 s28, v10
    s_cmp_ge_i32 s28, 2
    s_cbranch_scc0 L_ipa
    ds_read_b128 v[160:163], v12 offset:0
    ds_read_b128 v[164:167], v12 offset:4096
    ds_read_b128 v[168:171], v13 offset:0
    ds_read_b128 v[172:175], v13 offset:4096
    ds_read_b128 v[176:179], v14 offset:0
    ds_read_b128 v[180:183], v14 offset:4096
    ds_read_b128 v[184:187], v15 offset:0
    ds_read_b128 v[188:191], v15 offset:4096
    s_waitcnt lgkmcnt(0)
    v_mfma_f32_16x16x32_bf16 v[128:131], v[160:163], v[32:35], 0
    v_mfma_f32_16x16x32_bf16 v[132:135], v[160:163], v[48:51], 0
    v_mfma_f32_16x16x32_bf16 v[136:139], v[164:167], v[32:35], 0
    v_mfma_f32_16x16x32_bf16 v[140:143], v[164:167], v[48:51], 0
    v_mfma_f32_16x16x32_bf16 v[128:131], v[168:171], v[36:39], v[128:131]
    v_mfma_f32_16x16x32_bf16 v[132:135], v[168:171], v[52:55], v[132:135]
    v_mfma_f32_16x16x32_bf16 v[136:139], v[172:175], v[36:39], v[136:139]
    v_mfma_f32_16x16x32_bf16 v[140:143], v[172:175], v[52:55], v[140:143]
    v_mfma_f32_16x16x32_bf16 v[128:131], v[176:179], v[40:43], v[128:131]
    v_mfma_f32_16x16x32_bf16 v[132:135], v[176:179], v[56:59], v[132:135]
    v_mfma_f32_16x16x32_bf16 v[136:139], v[180:183], v[40:43], v[136:139]
    v_mfma_f32_16x16x32_bf16 v[140:143], v[180:183], v[56:59], v[140:143]
    v_mfma_f32_16x16x32_bf16 v[128:131], v[184:187], v[44:47], v[128:131]
    v_mfma_f32_16x16x32_bf16 v[132:135], v[184:187], v[60:63], v[132:135]
    v_mfma_f32_16x16x32_bf16 v[136:139], v[188:191], v[44:47], v[136:139]
    v_mfma_f32_16x16x32_bf16 v[140:143], v[188:191], v[60:63], v[140:143]
    ds_read_b128 v[160:163], v12 offset:8192
    ds_read_b128 v[164:167], v12 offset:12288
    ds_read_b128 v[168:171], v13 offset:8192
    ds_read_b128 v[172:175], v13 offset:12288
    ds_read_b128 v[176:179], v14 offset:8192
    ds_read_b128 v[180:183], v14 offset:12288
    ds_read_b128 v[184:187], v15 offset:8192
    ds_read_b128 v[188:191], v15 offset:12288
    s_mov_b32 s29, 4
L_ipb:
    ds_read_b32 v10, v1
    s_sub_u32 s25, s25, 1
    s_cbranch_scc1 L_end1
    s_waitcnt lgkmcnt(0)
    v_readfirstlane_b32 s28, v10
    s_cmp_ge_i32 s28, 4
    s_cbranch_scc0 L_ipb
.p2align 3
L_body0:
    v_mfma_f32_16x16x32_bf16 v[144:147], v[160:163], v[32:35], v[24:27]
    ds_read_b64_tr_b16 v[192:193], v16 offset:0
    ds_read_b64_tr_b16 v[194:195], v16 offset:4096
    v_exp_f32 v242, v140
    v_mfma_f32_16x16x32_bf16 v[148:151], v[160:163], v[48:51], v[28:31]
    ds_read_b64_tr_b16 v[196:197], v17 offset:0
    ds_read_b64_tr_b16 v[198:199], v17 offset:4096
    v_exp_f32 v243, v141
    v_mfma_f32_16x16x32_bf16 v[152:155], v[164:167], v[32:35], v[248:251]
    ds_read_b64_tr_b16 v[200:201], v18 offset:0
    v_add_f32 v2, v2, v240
    v_cvt_pk_bf16_f32 v226, v240, v241
    v_mfma_f32_16x16x32_bf16 v[156:159], v[164:167], v[48:51], v[252:255]
    ds_read_b64_tr_b16 v[202:203], v18 offset:4096
    v_add_f32 v2, v2, v241
    v_mfma_f32_16x16x32_bf16 v[144:147], v[168:171], v[36:39], v[144:147]
    ds_read_b64_tr_b16 v[204:205], v19 offset:0
    v_exp_f32 v244, v138
    v_mfma_f32_16x16x32_bf16 v[148:151], v[168:171], v[52:55], v[148:151]
    ds_read_b64_tr_b16 v[206:207], v19 offset:4096
    v_exp_f32 v245, v139
    v_mfma_f32_16x16x32_bf16 v[152:155], v[172:175], v[36:39], v[152:155]
    ds_read_b64_tr_b16 v[208:209], v20 offset:0
    v_add_f32 v3, v3, v242
    v_cvt_pk_bf16_f32 v230, v242, v243
    v_mfma_f32_16x16x32_bf16 v[156:159], v[172:175], v[52:55], v[156:159]
    ds_read_b64_tr_b16 v[210:211], v20 offset:4096
    v_add_f32 v3, v3, v243
    v_mfma_f32_16x16x32_bf16 v[144:147], v[176:179], v[40:43], v[144:147]
    ds_read_b64_tr_b16 v[212:213], v21 offset:0
    v_exp_f32 v246, v142
    v_mfma_f32_16x16x32_bf16 v[148:151], v[176:179], v[56:59], v[148:151]
    ds_read_b64_tr_b16 v[214:215], v21 offset:4096
    v_exp_f32 v247, v143
    v_add_f32 v2, v2, v244
    v_mfma_f32_16x16x32_bf16 v[152:155], v[180:183], v[40:43], v[152:155]
    ds_read_b64_tr_b16 v[216:217], v22 offset:0
    v_cvt_pk_bf16_f32 v227, v244, v245
    v_mfma_f32_16x16x32_bf16 v[156:159], v[180:183], v[56:59], v[156:159]
    ds_read_b64_tr_b16 v[218:219], v22 offset:4096
    v_add_f32 v2, v2, v245
    v_add_f32 v3, v3, v246
    v_mfma_f32_16x16x32_bf16 v[144:147], v[184:187], v[44:47], v[144:147]
    ds_read_b64_tr_b16 v[220:221], v23 offset:0
    v_cvt_pk_bf16_f32 v231, v246, v247
    v_add_f32 v3, v3, v247
    v_mfma_f32_16x16x32_bf16 v[148:151], v[184:187], v[60:63], v[148:151]
    ds_read_b64_tr_b16 v[222:223], v23 offset:4096
    v_add_f32 v11, v2, v3
    v_cmp_nge_f32 vcc, s27, v11
    v_mfma_f32_16x16x32_bf16 v[152:155], v[188:191], v[44:47], v[152:155]
    ds_read_b128 v[160:163], v12 offset:16384
    ds_read_b128 v[164:167], v12 offset:20480
    v_mfma_f32_16x16x32_bf16 v[156:159], v[188:191], v[60:63], v[156:159]
    s_waitcnt lgkmcnt(6)
    ds_read_b128 v[168:171], v13 offset:16384
    s_cbranch_vccnz L_stub0
L_cont0:
    v_mfma_f32_16x16x32_bf16 v[64:67], v[192:195], v[224:227], v[64:67]
    ds_read_b128 v[172:175], v13 offset:20480
    v_add_f32 v5, v5, v2
    v_mfma_f32_16x16x32_bf16 v[68:71], v[192:195], v[228:231], v[68:71]
    ds_read_b128 v[176:179], v14 offset:16384
    v_add_f32 v7, v7, v3
    v_mfma_f32_16x16x32_bf16 v[72:75], v[196:199], v[224:227], v[72:75]
    ds_read_b128 v[180:183], v14 offset:20480
    v_add_u32 v9, 1, v9
    v_mfma_f32_16x16x32_bf16 v[76:79], v[196:199], v[228:231], v[76:79]
    ds_read_b128 v[184:187], v15 offset:16384
    v_exp_f32 v240, v144
    v_mfma_f32_16x16x32_bf16 v[80:83], v[200:203], v[224:227], v[80:83]
    ds_read_b128 v[188:191], v15 offset:20480
    v_exp_f32 v241, v145
    v_mfma_f32_16x16x32_bf16 v[84:87], v[200:203], v[228:231], v[84:87]
    s_waitcnt lgkmcnt(8)
    ds_write_b32 v8, v9
    v_exp_f32 v242, v148
    v_mfma_f32_16x16x32_bf16 v[88:91], v[204:207], v[224:227], v[88:91]
    v_exp_f32 v243, v149
    v_add_f32 v2, v240, v241
    v_mfma_f32_16x16x32_bf16 v[92:95], v[204:207], v[228:231], v[92:95]
    v_cvt_pk_bf16_f32 v232, v240, v241
    v_exp_f32 v244, v146
    v_mfma_f32_16x16x32_bf16 v[96:99], v[208:211], v[224:227], v[96:99]
    v_exp_f32 v245, v147
    v_mfma_f32_16x16x32_bf16 v[100:103], v[208:211], v[228:231], v[100:103]
    v_add_f32 v3, v242, v243
    v_cvt_pk_bf16_f32 v236, v242, v243
    v_mfma_f32_16x16x32_bf16 v[104:107], v[212:215], v[224:227], v[104:107]
    v_exp_f32 v246, v150
    v_mfma_f32_16x16x32_bf16 v[108:111], v[212:215], v[228:231], v[108:111]
    v_exp_f32 v247, v151
    v_add_f32 v2, v2, v244
    v_mfma_f32_16x16x32_bf16 v[112:115], v[216:219], v[224:227], v[112:115]
    s_add_u32 s29, s29, 2
    v_cvt_pk_bf16_f32 v233, v244, v245
    v_add_f32 v2, v2, v245
    v_mfma_f32_16x16x32_bf16 v[116:119], v[216:219], v[228:231], v[116:119]
    s_cmp_ge_i32 s28, s29
    v_exp_f32 v240, v152
    v_mfma_f32_16x16x32_bf16 v[120:123], v[220:223], v[224:227], v[120:123]
    s_waitcnt lgkmcnt(0)
    v_exp_f32 v241, v153
    v_add_f32 v3, v3, v246
    v_mfma_f32_16x16x32_bf16 v[124:127], v[220:223], v[228:231], v[124:127]
    v_cvt_pk_bf16_f32 v237, v246, v247
    v_add_f32 v3, v3, v247
    s_cbranch_scc0 L_pent0
L_ok0:
L_body1:
    v_mfma_f32_16x16x32_bf16 v[128:131], v[160:163], v[32:35], v[24:27]
    ds_read_b64_tr_b16 v[192:193], v16 offset:8192
    ds_read_b64_tr_b16 v[194:195], v16 offset:12288
    v_exp_f32 v242, v156
    v_mfma_f32_16x16x32_bf16 v[132:135], v[160:163], v[48:51], v[28:31]
    ds_read_b64_tr_b16 v[196:197], v17 offset:8192
    ds_read_b64_tr_b16 v[198:199], v17 offset:12288
    v_exp_f32 v243, v157
    v_mfma_f32_16x16x32_bf16 v[136:139], v[164:167], v[32:35], v[248:251]
    ds_read_b64_tr_b16 v[200:201], v18 offset:8192
    v_add_f32 v2, v2, v240
    v_cvt_pk_bf16_f32 v234, v240, v241
    v_mfma_f32_16x16x32_bf16 v[140:143], v[164:167], v[48:51], v[252:255]
    ds_read_b64_tr_b16 v[202:203], v18 offset:12288
    v_add_f32 v2, v2, v241
    v_mfma_f32_16x16x32_bf16 v[128:131], v[168:171], v[36:39], v[128:131]
    ds_read_b64_tr_b16 v[204:205], v19 offset:8192
    v_exp_f32 v244, v154
    v_mfma_f32_16x16x32_bf16 v[132:135], v[168:171], v[52:55], v[132:135]
    ds_read_b64_tr_b16 v[206:207], v19 offset:12288
    v_exp_f32 v245, v155
    v_mfma_f32_16x16x32_bf16 v[136:139], v[172:175], v[36:39], v[136:139]
    ds_read_b64_tr_b16 v[208:209], v20 offset:8192
    v_add_f32 v3, v3, v242
    v_cvt_pk_bf16_f32 v238, v242, v243
    v_mfma_f32_16x16x32_bf16 v[140:143], v[172:175], v[52:55], v[140:143]
    ds_read_b64_tr_b16 v[210:211], v20 offset:12288
    v_add_f32 v3, v3, v243
    v_mfma_f32_16x16x32_bf16 v[128:131], v[176:179], v[40:43], v[128:131]
    ds_read_b64_tr_b16 v[212:213], v21 offset:8192
    v_exp_f32 v246, v158
    v_mfma_f32_16x16x32_bf16 v[132:135], v[176:179], v[56:59], v[132:135]
    ds_read_b64_tr_b16 v[214:215], v21 offset:12288
    v_exp_f32 v247, v159
    v_add_f32 v2, v2, v244
    v_mfma_f32_16x16x32_bf16 v[136:139], v[180:183], v[40:43], v[136:139]
    ds_read_b64_tr_b16 v[216:217], v22 offset:8192
    v_cvt_pk_bf16_f32 v235, v244, v245
    v_mfma_f32_16x16x32_bf16 v[140:143], v[180:183], v[56:59], v[140:143]
    ds_read_b64_tr_b16 v[218:219], v22 offset:12288
    v_add_f32 v2, v2, v245
    v_add_f32 v3, v3, v246
    v_mfma_f32_16x16x32_bf16 v[128:131], v[184:187], v[44:47], v[128:131]
    ds_read_b64_tr_b16 v[220:221], v23 offset:8192
    v_cvt_pk_bf16_f32 v239, v246, v247
    v_add_f32 v3, v3, v247
    v_mfma_f32_16x16x32_bf16 v[132:135], v[184:187], v[60:63], v[132:135]
    ds_read_b64_tr_b16 v[222:223], v23 offset:12288
    v_add_f32 v11, v2, v3
    v_cmp_nge_f32 vcc, s27, v11
    v_mfma_f32_16x16x32_bf16 v[136:139], v[188:191], v[44:47], v[136:139]
    ds_read_b128 v[160:163], v12 offset:24576
    ds_read_b128 v[164:167], v12 offset:28672
    v_mfma_f32_16x16x32_bf16 v[140:143], v[188:191], v[60:63], v[140:143]
    s_waitcnt lgkmcnt(6)
    ds_read_b128 v[168:171], v13 offset:24576
    s_cbranch_vccnz L_stub1
L_cont1:
    v_mfma_f32_16x16x32_bf16 v[64:67], v[192:195], v[232:235], v[64:67]
    ds_read_b128 v[172:175], v13 offset:28672
    v_add_f32 v5, v5, v2
    v_mfma_f32_16x16x32_bf16 v[68:71], v[192:195], v[236:239], v[68:71]
    ds_read_b128 v[176:179], v14 offset:24576
    v_add_f32 v7, v7, v3
    v_mfma_f32_16x16x32_bf16 v[72:75], v[196:199], v[232:235], v[72:75]
    ds_read_b128 v[180:183], v14 offset:28672
    v_add_u32 v9, 1, v9
    v_mfma_f32_16x16x32_bf16 v[76:79], v[196:199], v[236:239], v[76:79]
    ds_read_b128 v[184:187], v15 offset:24576
    v_exp_f32 v240, v128
    v_mfma_f32_16x16x32_bf16 v[80:83], v[200:203], v[232:235], v[80:83]
    ds_read_b128 v[188:191], v15 offset:28672
    v_exp_f32 v241, v129
    v_mfma_f32_16x16x32_bf16 v[84:87], v[200:203], v[236:239], v[84:87]
    s_waitcnt lgkmcnt(8)
    ds_write_b32 v8, v9
    v_exp_f32 v242, v132
    v_mfma_f32_16x16x32_bf16 v[88:91], v[204:207], v[232:235], v[88:91]
    v_exp_f32 v243, v133
    v_add_f32 v2, v240, v241
    v_mfma_f32_16x16x32_bf16 v[92:95], v[204:207], v[236:239], v[92:95]
    v_cvt_pk_bf16_f32 v224, v240, v241
    v_exp_f32 v244, v130
    v_mfma_f32_16x16x32_bf16 v[96:99], v[208:211], v[232:235], v[96:99]
    v_exp_f32 v245, v131
    v_mfma_f32_16x16x32_bf16 v[100:103], v[208:211], v[236:239], v[100:103]
    v_add_f32 v3, v242, v243
    v_cvt_pk_bf16_f32 v228, v242, v243
    v_mfma_f32_16x16x32_bf16 v[104:107], v[212:215], v[232:235], v[104:107]
    v_exp_f32 v246, v134
    v_mfma_f32_16x16x32_bf16 v[108:111], v[212:215], v[236:239], v[108:111]
    v_exp_f32 v247, v135
    v_add_f32 v2, v2, v244
    v_mfma_f32_16x16x32_bf16 v[112:115], v[216:219], v[232:235], v[112:115]
    s_add_u32 s29, s29, 2
    v_cvt_pk_bf16_f32 v225, v244, v245
    v_add_f32 v2, v2, v245
    v_mfma_f32_16x16x32_bf16 v[116:119], v[216:219], v[236:239], v[116:119]
    s_cmp_ge_i32 s28, s29
    v_exp_f32 v240, v136
    v_mfma_f32_16x16x32_bf16 v[120:123], v[220:223], v[232:235], v[120:123]
    s_waitcnt lgkmcnt(0)
    v_exp_f32 v241, v137
    v_add_f32 v3, v3, v246
    v_mfma_f32_16x16x32_bf16 v[124:127], v[220:223], v[236:239], v[124:127]
    v_cvt_pk_bf16_f32 v229, v246, v247
    v_add_f32 v3, v3, v247
    s_cbranch_scc0 L_pent1
L_ok1:
L_body2:
    v_mfma_f32_16x16x32_bf16 v[144:147], v[160:163], v[32:35], v[24:27]
    ds_read_b64_tr_b16 v[192:193], v16 offset:16384
    ds_read_b64_tr_b16 v[194:195], v16 offset:20480
    v_exp_f32 v242, v140
    v_mfma_f32_16x16x32_bf16 v[148:151], v[160:163], v[48:51], v[28:31]
    ds_read_b64_tr_b16 v[196:197], v17 offset:16384
    ds_read_b64_tr_b16 v[198:199], v17 offset:20480
    v_exp_f32 v243, v141
    v_mfma_f32_16x16x32_bf16 v[152:155], v[164:167], v[32:35], v[248:251]
    ds_read_b64_tr_b16 v[200:201], v18 offset:16384
    v_add_f32 v2, v2, v240
    v_cvt_pk_bf16_f32 v226, v240, v241
    v_mfma_f32_16x16x32_bf16 v[156:159], v[164:167], v[48:51], v[252:255]
    ds_read_b64_tr_b16 v[202:203], v18 offset:20480
    v_add_f32 v2, v2, v241
    v_mfma_f32_16x16x32_bf16 v[144:147], v[168:171], v[36:39], v[144:147]
    ds_read_b64_tr_b16 v[204:205], v19 offset:16384
    v_exp_f32 v244, v138
    v_mfma_f32_16x16x32_bf16 v[148:151], v[168:171], v[52:55], v[148:151]
    ds_read_b64_tr_b16 v[206:207], v19 offset:20480
    v_exp_f32 v245, v139
    v_mfma_f32_16x16x32_bf16 v[152:155], v[172:175], v[36:39], v[152:155]
    ds_read_b64_tr_b16 v[208:209], v20 offset:16384
    v_add_f32 v3, v3, v242
    v_cvt_pk_bf16_f32 v230, v242, v243
    v_mfma_f32_16x16x32_bf16 v[156:159], v[172:175], v[52:55], v[156:159]
    ds_read_b64_tr_b16 v[210:211], v20 offset:20480
    v_add_f32 v3, v3, v243
    v_mfma_f32_16x16x32_bf16 v[144:147], v[176:179], v[40:43], v[144:147]
    ds_read_b64_tr_b16 v[212:213], v21 offset:16384
    v_exp_f32 v246, v142
    v_mfma_f32_16x16x32_bf16 v[148:151], v[176:179], v[56:59], v[148:151]
    ds_read_b64_tr_b16 v[214:215], v21 offset:20480
    v_exp_f32 v247, v143
    v_add_f32 v2, v2, v244
    v_mfma_f32_16x16x32_bf16 v[152:155], v[180:183], v[40:43], v[152:155]
    ds_read_b64_tr_b16 v[216:217], v22 offset:16384
    v_cvt_pk_bf16_f32 v227, v244, v245
    v_mfma_f32_16x16x32_bf16 v[156:159], v[180:183], v[56:59], v[156:159]
    ds_read_b64_tr_b16 v[218:219], v22 offset:20480
    v_add_f32 v2, v2, v245
    v_add_f32 v3, v3, v246
    v_mfma_f32_16x16x32_bf16 v[144:147], v[184:187], v[44:47], v[144:147]
    ds_read_b64_tr_b16 v[220:221], v23 offset:16384
    v_cvt_pk_bf16_f32 v231, v246, v247
    v_add_f32 v3, v3, v247
    v_mfma_f32_16x16x32_bf16 v[148:151], v[184:187], v[60:63], v[148:151]
    ds_read_b64_tr_b16 v[222:223], v23 offset:20480
    v_add_f32 v11, v2, v3
    v_cmp_nge_f32 vcc, s27, v11
    v_mfma_f32_16x16x32_bf16 v[152:155], v[188:191], v[44:47], v[152:155]
    ds_read_b128 v[160:163], v12 offset:32768
    ds_read_b128 v[164:167], v12 offset:36864
    v_mfma_f32_16x16x32_bf16 v[156:159], v[188:191], v[60:63], v[156:159]
    s_waitcnt lgkmcnt(6)
    ds_read_b128 v[168:171], v13 offset:32768
    s_cbranch_vccnz L_stub2
L_cont2:
    v_mfma_f32_16x16x32_bf16 v[64:67], v[192:195], v[224:227], v[64:67]
    ds_read_b128 v[172:175], v13 offset:36864
    v_add_f32 v5, v5, v2
    v_mfma_f32_16x16x32_bf16 v[68:71], v[192:195], v[228:231], v[68:71]
    ds_read_b128 v[176:179], v14 offset:32768
    v_add_f32 v7, v7, v3
    v_mfma_f32_16x16x32_bf16 v[72:75], v[196:199], v[224:227], v[72:75]
    ds_read_b128 v[180:183], v14 offset:36864
    v_add_u32 v9, 1, v9
    v_mfma_f32_16x16x32_bf16 v[76:79], v[196:199], v[228:231], v[76:79]
    ds_read_b128 v[184:187], v15 offset:32768
    v_exp_f32 v240, v144
    v_mfma_f32_16x16x32_bf16 v[80:83], v[200:203], v[224:227], v[80:83]
    ds_read_b128 v[188:191], v15 offset:36864
    v_exp_f32 v241, v145
    v_mfma_f32_16x16x32_bf16 v[84:87], v[200:203], v[228:231], v[84:87]
    s_waitcnt lgkmcnt(8)
    ds_write_b32 v8, v9
    v_exp_f32 v242, v148
    v_mfma_f32_16x16x32_bf16 v[88:91], v[204:207], v[224:227], v[88:91]
    v_exp_f32 v243, v149
    v_add_f32 v2, v240, v241
    v_mfma_f32_16x16x32_bf16 v[92:95], v[204:207], v[228:231], v[92:95]
    v_cvt_pk_bf16_f32 v232, v240, v241
    v_exp_f32 v244, v146
    v_mfma_f32_16x16x32_bf16 v[96:99], v[208:211], v[224:227], v[96:99]
    v_exp_f32 v245, v147
    v_mfma_f32_16x16x32_bf16 v[100:103], v[208:211], v[228:231], v[100:103]
    v_add_f32 v3, v242, v243
    v_cvt_pk_bf16_f32 v236, v242, v243
    v_mfma_f32_16x16x32_bf16 v[104:107], v[212:215], v[224:227], v[104:107]
    v_exp_f32 v246, v150
    v_mfma_f32_16x16x32_bf16 v[108:111], v[212:215], v[228:231], v[108:111]
    v_exp_f32 v247, v151
    v_add_f32 v2, v2, v244
    v_mfma_f32_16x16x32_bf16 v[112:115], v[216:219], v[224:227], v[112:115]
    s_add_u32 s29, s29, 2
    v_cvt_pk_bf16_f32 v233, v244, v245
    v_add_f32 v2, v2, v245
    v_mfma_f32_16x16x32_bf16 v[116:119], v[216:219], v[228:231], v[116:119]
    s_cmp_ge_i32 s28, s29
    v_exp_f32 v240, v152
    v_mfma_f32_16x16x32_bf16 v[120:123], v[220:223], v[224:227], v[120:123]
    s_waitcnt lgkmcnt(0)
    v_exp_f32 v241, v153
    v_add_f32 v3, v3, v246
    v_mfma_f32_16x16x32_bf16 v[124:127], v[220:223], v[228:231], v[124:127]
    v_cvt_pk_bf16_f32 v237, v246, v247
    v_add_f32 v3, v3, v247
    s_cbranch_scc0 L_pent2
L_ok2:
L_body3:
    v_mfma_f32_16x16x32_bf16 v[128:131], v[160:163], v[32:35], v[24:27]
    ds_read_b64_tr_b16 v[192:193], v16 offset:24576
    ds_read_b64_tr_b16 v[194:195], v16 offset:28672
    v_exp_f32 v242, v156
    v_mfma_f32_16x16x32_bf16 v[132:135], v[160:163], v[48:51], v[28:31]
    ds_read_b64_tr_b16 v[196:197], v17 offset:24576
    ds_read_b64_tr_b16 v[198:199], v17 offset:28672
    v_exp_f32 v243, v157
    v_mfma_f32_16x16x32_bf16 v[136:139], v[164:167], v[32:35], v[248:251]
    ds_read_b64_tr_b16 v[200:201], v18 offset:24576
    v_add_f32 v2, v2, v240
    v_cvt_pk_bf16_f32 v234, v240, v241
    v_mfma_f32_16x16x32_bf16 v[140:143], v[164:167], v[48:51], v[252:255]
    ds_read_b64_tr_b16 v[202:203], v18 offset:28672
    v_add_f32 v2, v2, v241
    v_mfma_f32_16x16x32_bf16 v[128:131], v[168:171], v[36:39], v[128:131]
    ds_read_b64_tr_b16 v[204:205], v19 offset:24576
    v_exp_f32 v244, v154
    v_mfma_f32_16x16x32_bf16 v[132:135], v[168:171], v[52:55], v[132:135]
    ds_read_b64_tr_b16 v[206:207], v19 offset:28672
    v_exp_f32 v245, v155
    v_mfma_f32_16x16x32_bf16 v[136:139], v[172:175], v[36:39], v[136:139]
    ds_read_b64_tr_b16 v[208:209], v20 offset:24576
    v_add_f32 v3, v3, v242
    v_cvt_pk_bf16_f32 v238, v242, v243
    v_mfma_f32_16x16x32_bf16 v[140:143], v[172:175], v[52:55], v[140:143]
    ds_read_b64_tr_b16 v[210:211], v20 offset:28672
    v_add_f32 v3, v3, v243
    v_mfma_f32_16x16x32_bf16 v[128:131], v[176:179], v[40:43], v[128:131]
    ds_read_b64_tr_b16 v[212:213], v21 offset:24576
    v_exp_f32 v246, v158
    v_mfma_f32_16x16x32_bf16 v[132:135], v[176:179], v[56:59], v[132:135]
    ds_read_b64_tr_b16 v[214:215], v21 offset:28672
    v_exp_f32 v247, v159
    v_add_f32 v2, v2, v244
    v_mfma_f32_16x16x32_bf16 v[136:139], v[180:183], v[40:43], v[136:139]
    ds_read_b64_tr_b16 v[216:217], v22 offset:24576
    v_cvt_pk_bf16_f32 v235, v244, v245
    v_mfma_f32_16x16x32_bf16 v[140:143], v[180:183], v[56:59], v[140:143]
    ds_read_b64_tr_b16 v[218:219], v22 offset:28672
    v_add_f32 v2, v2, v245
    v_add_f32 v3, v3, v246
    v_mfma_f32_16x16x32_bf16 v[128:131], v[184:187], v[44:47], v[128:131]
    ds_read_b64_tr_b16 v[220:221], v23 offset:24576
    v_cvt_pk_bf16_f32 v239, v246, v247
    v_add_f32 v3, v3, v247
    v_mfma_f32_16x16x32_bf16 v[132:135], v[184:187], v[60:63], v[132:135]
    ds_read_b64_tr_b16 v[222:223], v23 offset:28672
    v_add_f32 v11, v2, v3
    v_cmp_nge_f32 vcc, s27, v11
    v_mfma_f32_16x16x32_bf16 v[136:139], v[188:191], v[44:47], v[136:139]
    ds_read_b128 v[160:163], v12 offset:40960
    ds_read_b128 v[164:167], v12 offset:45056
    v_mfma_f32_16x16x32_bf16 v[140:143], v[188:191], v[60:63], v[140:143]
    s_waitcnt lgkmcnt(6)
    ds_read_b128 v[168:171], v13 offset:40960
    s_cbranch_vccnz L_stub3
L_cont3:
    v_mfma_f32_16x16x32_bf16 v[64:67], v[192:195], v[232:235], v[64:67]
    ds_read_b128 v[172:175], v13 offset:45056
    v_add_f32 v5, v5, v2
    v_mfma_f32_16x16x32_bf16 v[68:71], v[192:195], v[236:239], v[68:71]
    ds_read_b128 v[176:179], v14 offset:40960
    v_add_f32 v7, v7, v3
    v_mfma_f32_16x16x32_bf16 v[72:75], v[196:199], v[232:235], v[72:75]
    ds_read_b128 v[180:183], v14 offset:45056
    v_add_u32 v9, 1, v9
    v_mfma_f32_16x16x32_bf16 v[76:79], v[196:199], v[236:239], v[76:79]
    ds_read_b128 v[184:187], v15 offset:40960
    v_exp_f32 v240, v128
    v_mfma_f32_16x16x32_bf16 v[80:83], v[200:203], v[232:235], v[80:83]
    ds_read_b128 v[188:191], v15 offset:45056
    v_exp_f32 v241, v129
    v_mfma_f32_16x16x32_bf16 v[84:87], v[200:203], v[236:239], v[84:87]
    s_waitcnt lgkmcnt(8)
    ds_write_b32 v8, v9
    v_exp_f32 v242, v132
    v_mfma_f32_16x16x32_bf16 v[88:91], v[204:207], v[232:235], v[88:91]
    v_exp_f32 v243, v133
    v_add_f32 v2, v240, v241
    v_mfma_f32_16x16x32_bf16 v[92:95], v[204:207], v[236:239], v[92:95]
    v_cvt_pk_bf16_f32 v224, v240, v241
    v_exp_f32 v244, v130
    v_mfma_f32_16x16x32_bf16 v[96:99], v[208:211], v[232:235], v[96:99]
    v_exp_f32 v245, v131
    v_mfma_f32_16x16x32_bf16 v[100:103], v[208:211], v[236:239], v[100:103]
    v_add_f32 v3, v242, v243
    v_cvt_pk_bf16_f32 v228, v242, v243
    v_mfma_f32_16x16x32_bf16 v[104:107], v[212:215], v[232:235], v[104:107]
    v_exp_f32 v246, v134
    v_mfma_f32_16x16x32_bf16 v[108:111], v[212:215], v[236:239], v[108:111]
    v_exp_f32 v247, v135
    v_add_f32 v2, v2, v244
    v_mfma_f32_16x16x32_bf16 v[112:115], v[216:219], v[232:235], v[112:115]
    s_add_u32 s29, s29, 2
    v_cvt_pk_bf16_f32 v225, v244, v245
    v_add_f32 v2, v2, v245
    v_mfma_f32_16x16x32_bf16 v[116:119], v[216:219], v[236:239], v[116:119]
    s_cmp_ge_i32 s28, s29
    v_exp_f32 v240, v136
    v_mfma_f32_16x16x32_bf16 v[120:123], v[220:223], v[232:235], v[120:123]
    s_waitcnt lgkmcnt(0)
    v_exp_f32 v241, v137
    v_add_f32 v3, v3, v246
    v_mfma_f32_16x16x32_bf16 v[124:127], v[220:223], v[236:239], v[124:127]
    v_cvt_pk_bf16_f32 v229, v246, v247
    v_add_f32 v3, v3, v247
    s_cbranch_scc0 L_pent3
L_ok3:
L_body4:
    v_mfma_f32_16x16x32_bf16 v[144:147], v[160:163], v[32:35], v[24:27]
    ds_read_b64_tr_b16 v[192:193], v16 offset:32768
    ds_read_b64_tr_b16 v[194:195], v16 offset:36864
    v_exp_f32 v242, v140
    v_mfma_f32_16x16x32_bf16 v[148:151], v[160:163], v[48:51], v[28:31]
    ds_read_b64_tr_b16 v[196:197], v17 offset:32768
    ds_read_b64_tr_b16 v[198:199], v17 offset:36864
    v_exp_f32 v243, v141
    v_mfma_f32_16x16x32_bf16 v[152:155], v[164:167], v[32:35], v[248:251]
    ds_read_b64_tr_b16 v[200:201], v18 offset:32768
    v_add_f32 v2, v2, v240
    v_cvt_pk_bf16_f32 v226, v240, v241
    v_mfma_f32_16x16x32_bf16 v[156:159], v[164:167], v[48:51], v[252:255]
    ds_read_b64_tr_b16 v[202:203], v18 offset:36864
    v_add_f32 v2, v2, v241
    v_mfma_f32_16x16x32_bf16 v[144:147], v[168:171], v[36:39], v[144:147]
    ds_read_b64_tr_b16 v[204:205], v19 offset:32768
    v_exp_f32 v244, v138
    v_mfma_f32_16x16x32_bf16 v[148:151], v[168:171], v[52:55], v[148:151]
    ds_read_b64_tr_b16 v[206:207], v19 offset:36864
    v_exp_f32 v245, v139
    v_mfma_f32_16x16x32_bf16 v[152:155], v[172:175], v[36:39], v[152:155]
    ds_read_b64_tr_b16 v[208:209], v20 offset:32768
    v_add_f32 v3, v3, v242
    v_cvt_pk_bf16_f32 v230, v242, v243
    v_mfma_f32_16x16x32_bf16 v[156:159], v[172:175], v[52:55], v[156:159]
    ds_read_b64_tr_b16 v[210:211], v20 offset:36864
    v_add_f32 v3, v3, v243
    v_mfma_f32_16x16x32_bf16 v[144:147], v[176:179], v[40:43], v[144:147]
    ds_read_b64_tr_b16 v[212:213], v21 offset:32768
    v_exp_f32 v246, v142
    v_mfma_f32_16x16x32_bf16 v[148:151], v[176:179], v[56:59], v[148:151]
    ds_read_b64_tr_b16 v[214:215], v21 offset:36864
    v_exp_f32 v247, v143
    v_add_f32 v2, v2, v244
    v_mfma_f32_16x16x32_bf16 v[152:155], v[180:183], v[40:43], v[152:155]
    ds_read_b64_tr_b16 v[216:217], v22 offset:32768
    v_cvt_pk_bf16_f32 v227, v244, v245
    v_mfma_f32_16x16x32_bf16 v[156:159], v[180:183], v[56:59], v[156:159]
    ds_read_b64_tr_b16 v[218:219], v22 offset:36864
    v_add_f32 v2, v2, v245
    v_add_f32 v3, v3, v246
    v_mfma_f32_16x16x32_bf16 v[144:147], v[184:187], v[44:47], v[144:147]
    ds_read_b64_tr_b16 v[220:221], v23 offset:32768
    v_cvt_pk_bf16_f32 v231, v246, v247
    v_add_f32 v3, v3, v247
    v_mfma_f32_16x16x32_bf16 v[148:151], v[184:187], v[60:63], v[148:151]
    ds_read_b64_tr_b16 v[222:223], v23 offset:36864
    v_add_f32 v11, v2, v3
    v_cmp_nge_f32 vcc, s27, v11
    v_mfma_f32_16x16x32_bf16 v[152:155], v[188:191], v[44:47], v[152:155]
    ds_read_b128 v[160:163], v12 offset:49152
    ds_read_b128 v[164:167], v12 offset:53248
    v_mfma_f32_16x16x32_bf16 v[156:159], v[188:191], v[60:63], v[156:159]
    s_waitcnt lgkmcnt(6)
    ds_read_b128 v[168:171], v13 offset:49152
    s_cbranch_vccnz L_stub4
L_cont4:
    v_mfma_f32_16x16x32_bf16 v[64:67], v[192:195], v[224:227], v[64:67]
    ds_read_b128 v[172:175], v13 offset:53248
    v_add_f32 v5, v5, v2
    v_mfma_f32_16x16x32_bf16 v[68:71], v[192:195], v[228:231], v[68:71]
    ds_read_b128 v[176:179], v14 offset:49152
    v_add_f32 v7, v7, v3
    v_mfma_f32_16x16x32_bf16 v[72:75], v[196:199], v[224:227], v[72:75]
    ds_read_b128 v[180:183], v14 offset:53248
    v_add_u32 v9, 1, v9
    v_mfma_f32_16x16x32_bf16 v[76:79], v[196:199], v[228:231], v[76:79]
    ds_read_b128 v[184:187], v15 offset:49152
    v_exp_f32 v240, v144
    v_mfma_f32_16x16x32_bf16 v[80:83], v[200:203], v[224:227], v[80:83]
    ds_read_b128 v[188:191], v15 offset:53248
    v_exp_f32 v241, v145
    v_mfma_f32_16x16x32_bf16 v[84:87], v[200:203], v[228:231], v[84:87]
    s_waitcnt lgkmcnt(8)
    ds_write_b32 v8, v9
    v_exp_f32 v242, v148
    v_mfma_f32_16x16x32_bf16 v[88:91], v[204:207], v[224:227], v[88:91]
    v_exp_f32 v243, v149
    v_add_f32 v2, v240, v241
    v_mfma_f32_16x16x32_bf16 v[92:95], v[204:207], v[228:231], v[92:95]
    v_cvt_pk_bf16_f32 v232, v240, v241
    v_exp_f32 v244, v146
    v_mfma_f32_16x16x32_bf16 v[96:99], v[208:211], v[224:227], v[96:99]
    v_exp_f32 v245, v147
    v_mfma_f32_16x16x32_bf16 v[100:103], v[208:211], v[228:231], v[100:103]
    v_add_f32 v3, v242, v243
    v_cvt_pk_bf16_f32 v236, v242, v243
    v_mfma_f32_16x16x32_bf16 v[104:107], v[212:215], v[224:227], v[104:107]
    v_exp_f32 v246, v150
    v_mfma_f32_16x16x32_bf16 v[108:111], v[212:215], v[228:231], v[108:111]
    v_exp_f32 v247, v151
    v_add_f32 v2, v2, v244
    v_mfma_f32_16x16x32_bf16 v[112:115], v[216:219], v[224:227], v[112:115]
    s_add_u32 s29, s29, 2
    v_cvt_pk_bf16_f32 v233, v244, v245
    v_add_f32 v2, v2, v245
    v_mfma_f32_16x16x32_bf16 v[116:119], v[216:219], v[228:231], v[116:119]
    s_cmp_ge_i32 s28, s29
    v_exp_f32 v240, v152
    v_mfma_f32_16x16x32_bf16 v[120:123], v[220:223], v[224:227], v[120:123]
    s_waitcnt lgkmcnt(0)
    v_exp_f32 v241, v153
    v_add_f32 v3, v3, v246
    v_mfma_f32_16x16x32_bf16 v[124:127], v[220:223], v[228:231], v[124:127]
    v_cvt_pk_bf16_f32 v237, v246, v247
    v_add_f32 v3, v3, v247
    s_cbranch_scc0 L_pent4
L_ok4:
L_body5:
    v_mfma_f32_16x16x32_bf16 v[128:131], v[160:163], v[32:35], v[24:27]
    ds_read_b64_tr_b16 v[192:193], v16 offset:40960
    ds_read_b64_tr_b16 v[194:195], v16 offset:45056
    v_exp_f32 v242, v156
    v_mfma_f32_16x16x32_bf16 v[132:135], v[160:163], v[48:51], v[28:31]
    ds_read_b64_tr_b16 v[196:197], v17 offset:40960
    ds_read_b64_tr_b16 v[198:199], v17 offset:45056
    v_exp_f32 v243, v157
    v_mfma_f32_16x16x32_bf16 v[136:139], v[164:167], v[32:35], v[248:251]
    ds_read_b64_tr_b16 v[200:201], v18 offset:40960
    v_add_f32 v2, v2, v240
    v_cvt_pk_bf16_f32 v234, v240, v241
    v_mfma_f32_16x16x32_bf16 v[140:143], v[164:167], v[48:51], v[252:255]
    ds_read_b64_tr_b16 v[202:203], v18 offset:45056
    v_add_f32 v2, v2, v241
    v_mfma_f32_16x16x32_bf16 v[128:131], v[168:171], v[36:39], v[128:131]
    ds_read_b64_tr_b16 v[204:205], v19 offset:40960
    v_exp_f32 v244, v154
    v_mfma_f32_16x16x32_bf16 v[132:135], v[168:171], v[52:55], v[132:135]
    ds_read_b64_tr_b16 v[206:207], v19 offset:45056
    v_exp_f32 v245, v155
    v_mfma_f32_16x16x32_bf16 v[136:139], v[172:175], v[36:39], v[136:139]
    ds_read_b64_tr_b16 v[208:209], v20 offset:40960
    v_add_f32 v3, v3, v242
    v_cvt_pk_bf16_f32 v238, v242, v243
    v_mfma_f32_16x16x32_bf16 v[140:143], v[172:175], v[52:55], v[140:143]
    ds_read_b64_tr_b16 v[210:211], v20 offset:45056
    v_add_f32 v3, v3, v243
    v_mfma_f32_16x16x32_bf16 v[128:131], v[176:179], v[40:43], v[128:131]
    ds_read_b64_tr_b16 v[212:213], v21 offset:40960
    v_exp_f32 v246, v158
    v_mfma_f32_16x16x32_bf16 v[132:135], v[176:179], v[56:59], v[132:135]
    ds_read_b64_tr_b16 v[214:215], v21 offset:45056
    v_exp_f32 v247, v159
    v_add_f32 v2, v2, v244
    v_mfma_f32_16x16x32_bf16 v[136:139], v[180:183], v[40:43], v[136:139]
    ds_read_b64_tr_b16 v[216:217], v22 offset:40960
    v_cvt_pk_bf16_f32 v235, v244, v245
    v_mfma_f32_16x16x32_bf16 v[140:143], v[180:183], v[56:59], v[140:143]
    ds_read_b64_tr_b16 v[218:219], v22 offset:45056
    v_add_f32 v2, v2, v245
    v_add_f32 v3, v3, v246
    v_mfma_f32_16x16x32_bf16 v[128:131], v[184:187], v[44:47], v[128:131]
    ds_read_b64_tr_b16 v[220:221], v23 offset:40960
    v_cvt_pk_bf16_f32 v239, v246, v247
    v_add_f32 v3, v3, v247
    v_mfma_f32_16x16x32_bf16 v[132:135], v[184:187], v[60:63], v[132:135]
    ds_read_b64_tr_b16 v[222:223], v23 offset:45056
    v_add_f32 v11, v2, v3
    v_cmp_nge_f32 vcc, s27, v11
    v_mfma_f32_16x16x32_bf16 v[136:139], v[188:191], v[44:47], v[136:139]
    ds_read_b128 v[160:163], v12 offset:57344
    ds_read_b128 v[164:167], v12 offset:61440
    v_mfma_f32_16x16x32_bf16 v[140:143], v[188:191], v[60:63], v[140:143]
    s_waitcnt lgkmcnt(6)
    ds_read_b128 v[168:171], v13 offset:57344
    s_cbranch_vccnz L_stub5
L_cont5:
    v_mfma_f32_16x16x32_bf16 v[64:67], v[192:195], v[232:235], v[64:67]
    ds_read_b128 v[172:175], v13 offset:61440
    v_add_f32 v5, v5, v2
    v_mfma_f32_16x16x32_bf16 v[68:71], v[192:195], v[236:239], v[68:71]
    ds_read_b128 v[176:179], v14 offset:57344
    v_add_f32 v7, v7, v3
    v_mfma_f32_16x16x32_bf16 v[72:75], v[196:199], v[232:235], v[72:75]
    ds_read_b128 v[180:183], v14 offset:61440
    v_add_u32 v9, 1, v9
    v_mfma_f32_16x16x32_bf16 v[76:79], v[196:199], v[236:239], v[76:79]
    ds_read_b128 v[184:187], v15 offset:57344
    v_exp_f32 v240, v128
    v_mfma_f32_16x16x32_bf16 v[80:83], v[200:203], v[232:235], v[80:83]
    ds_read_b128 v[188:191], v15 offset:61440
    v_exp_f32 v241, v129
    v_mfma_f32_16x16x32_bf16 v[84:87], v[200:203], v[236:239], v[84:87]
    s_waitcnt lgkmcnt(8)
    ds_write_b32 v8, v9
    v_exp_f32 v242, v132
    v_mfma_f32_16x16x32_bf16 v[88:91], v[204:207], v[232:235], v[88:91]
    v_exp_f32 v243, v133
    v_add_f32 v2, v240, v241
    v_mfma_f32_16x16x32_bf16 v[92:95], v[204:207], v[236:239], v[92:95]
    v_cvt_pk_bf16_f32 v224, v240, v241
    v_exp_f32 v244, v130
    v_mfma_f32_16x16x32_bf16 v[96:99], v[208:211], v[232:235], v[96:99]
    v_exp_f32 v245, v131
    v_mfma_f32_16x16x32_bf16 v[100:103], v[208:211], v[236:239], v[100:103]
    v_add_f32 v3, v242, v243
    v_cvt_pk_bf16_f32 v228, v242, v243
    v_mfma_f32_16x16x32_bf16 v[104:107], v[212:215], v[232:235], v[104:107]
    v_exp_f32 v246, v134
    v_mfma_f32_16x16x32_bf16 v[108:111], v[212:215], v[236:239], v[108:111]
    v_exp_f32 v247, v135
    v_add_f32 v2, v2, v244
    v_mfma_f32_16x16x32_bf16 v[112:115], v[216:219], v[232:235], v[112:115]
    s_add_u32 s29, s29, 2
    v_cvt_pk_bf16_f32 v225, v244, v245
    v_add_f32 v2, v2, v245
    v_mfma_f32_16x16x32_bf16 v[116:119], v[216:219], v[236:239], v[116:119]
    s_cmp_ge_i32 s28, s29
    v_exp_f32 v240, v136
    v_mfma_f32_16x16x32_bf16 v[120:123], v[220:223], v[232:235], v[120:123]
    s_waitcnt lgkmcnt(0)
    v_exp_f32 v241, v137
    v_add_f32 v3, v3, v246
    v_mfma_f32_16x16x32_bf16 v[124:127], v[220:223], v[236:239], v[124:127]
    v_cvt_pk_bf16_f32 v229, v246, v247
    v_add_f32 v3, v3, v247
    s_cbranch_scc0 L_pent5
L_ok5:
L_body6:
    v_mfma_f32_16x16x32_bf16 v[144:147], v[160:163], v[32:35], v[24:27]
    ds_read_b64_tr_b16 v[192:193], v16 offset:49152
    ds_read_b64_tr_b16 v[194:195], v16 offset:53248
    v_exp_f32 v242, v140
    v_mfma_f32_16x16x32_bf16 v[148:151], v[160:163], v[48:51], v[28:31]
    ds_read_b64_tr_b16 v[196:197], v17 offset:49152
    ds_read_b64_tr_b16 v[198:199], v17 offset:53248
    v_exp_f32 v243, v141
    v_mfma_f32_16x16x32_bf16 v[152:155], v[164:167], v[32:35], v[248:251]
    ds_read_b64_tr_b16 v[200:201], v18 offset:49152
    v_add_f32 v2, v2, v240
    v_cvt_pk_bf16_f32 v226, v240, v241
    v_mfma_f32_16x16x32_bf16 v[156:159], v[164:167], v[48:51], v[252:255]
    ds_read_b64_tr_b16 v[202:203], v18 offset:53248
    v_add_f32 v2, v2, v241
    v_mfma_f32_16x16x32_bf16 v[144:147], v[168:171], v[36:39], v[144:147]
    ds_read_b64_tr_b16 v[204:205], v19 offset:49152
    v_exp_f32 v244, v138
    v_mfma_f32_16x16x32_bf16 v[148:151], v[168:171], v[52:55], v[148:151]
    ds_read_b64_tr_b16 v[206:207], v19 offset:53248
    v_exp_f32 v245, v139
    v_mfma_f32_16x16x32_bf16 v[152:155], v[172:175], v[36:39], v[152:155]
    ds_read_b64_tr_b16 v[208:209], v20 offset:49152
    v_add_f32 v3, v3, v242
    v_cvt_pk_bf16_f32 v230, v242, v243
    v_mfma_f32_16x16x32_bf16 v[156:159], v[172:175], v[52:55], v[156:159]
    ds_read_b64_tr_b16 v[210:211], v20 offset:53248
    v_add_f32 v3, v3, v243
    v_mfma_f32_16x16x32_bf16 v[144:147], v[176:179], v[40:43], v[144:147]
    ds_read_b64_tr_b16 v[212:213], v21 offset:49152
    v_exp_f32 v246, v142
    v_mfma_f32_16x16x32_bf16 v[148:151], v[176:179], v[56:59], v[148:151]
    ds_read_b64_tr_b16 v[214:215], v21 offset:53248
    v_exp_f32 v247, v143
    v_add_f32 v2, v2, v244
    v_mfma_f32_16x16x32_bf16 v[152:155], v[180:183], v[40:43], v[152:155]
    ds_read_b64_tr_b16 v[216:217], v22 offset:49152
    v_cvt_pk_bf16_f32 v227, v244, v245
    v_mfma_f32_16x16x32_bf16 v[156:159], v[180:183], v[56:59], v[156:159]
    ds_read_b64_tr_b16 v[218:219], v22 offset:53248
    v_add_f32 v2, v2, v245
    v_add_f32 v3, v3, v246
    v_mfma_f32_16x16x32_bf16 v[144:147], v[184:187], v[44:47], v[144:147]
    ds_read_b64_tr_b16 v[220:221], v23 offset:49152
    v_cvt_pk_bf16_f32 v231, v246, v247
    v_add_f32 v3, v3, v247
    v_mfma_f32_16x16x32_bf16 v[148:151], v[184:187], v[60:63], v[148:151]
    ds_read_b64_tr_b16 v[222:223], v23 offset:53248
    v_add_f32 v11, v2, v3
    v_cmp_nge_f32 vcc, s27, v11
    v_mfma_f32_16x16x32_bf16 v[152:155], v[188:191], v[44:47], v[152:155]
    ds_read_b128 v[160:163], v12 offset:0
    ds_read_b128 v[164:167], v12 offset:4096
    v_mfma_f32_16x16x32_bf16 v[156:159], v[188:191], v[60:63], v[156:159]
    s_waitcnt lgkmcnt(6)
    ds_read_b128 v[168:171], v13 offset:0
    s_cbranch_vccnz L_stub6
L_cont6:
    v_mfma_f32_16x16x32_bf16 v[64:67], v[192:195], v[224:227], v[64:67]
    ds_read_b128 v[172:175], v13 offset:4096
    v_add_f32 v5, v5, v2
    v_mfma_f32_16x16x32_bf16 v[68:71], v[192:195], v[228:231], v[68:71]
    ds_read_b128 v[176:179], v14 offset:0
    v_add_f32 v7, v7, v3
    v_mfma_f32_16x16x32_bf16 v[72:75], v[196:199], v[224:227], v[72:75]
    ds_read_b128 v[180:183], v14 offset:4096
    v_add_u32 v9, 1, v9
    v_mfma_f32_16x16x32_bf16 v[76:79], v[196:199], v[228:231], v[76:79]
    ds_read_b128 v[184:187], v15 offset:0
    v_exp_f32 v240, v144
    v_mfma_f32_16x16x32_bf16 v[80:83], v[200:203], v[224:227], v[80:83]
    ds_read_b128 v[188:191], v15 offset:4096
    v_exp_f32 v241, v145
    v_mfma_f32_16x16x32_bf16 v[84:87], v[200:203], v[228:231], v[84:87]
    s_waitcnt lgkmcnt(8)
    ds_write_b32 v8, v9
    v_exp_f32 v242, v148
    v_mfma_f32_16x16x32_bf16 v[88:91], v[204:207], v[224:227], v[88:91]
    v_exp_f32 v243, v149
    v_add_f32 v2, v240, v241
    v_mfma_f32_16x16x32_bf16 v[92:95], v[204:207], v[228:231], v[92:95]
    v_cvt_pk_bf16_f32 v232, v240, v241
    v_exp_f32 v244, v146
    v_mfma_f32_16x16x32_bf16 v[96:99], v[208:211], v[224:227], v[96:99]
    v_exp_f32 v245, v147
    v_mfma_f32_16x16x32_bf16 v[100:103], v[208:211], v[228:231], v[100:103]
    v_add_f32 v3, v242, v243
    v_cvt_pk_bf16_f32 v236, v242, v243
    v_mfma_f32_16x16x32_bf16 v[104:107], v[212:215], v[224:227], v[104:107]
    v_exp_f32 v246, v150
    v_mfma_f32_16x16x32_bf16 v[108:111], v[212:215], v[228:231], v[108:111]
    v_exp_f32 v247, v151
    v_add_f32 v2, v2, v244
    v_mfma_f32_16x16x32_bf16 v[112:115], v[216:219], v[224:227], v[112:115]
    s_add_u32 s29, s29, 2
    v_cvt_pk_bf16_f32 v233, v244, v245
    v_add_f32 v2, v2, v245
    v_mfma_f32_16x16x32_bf16 v[116:119], v[216:219], v[228:231], v[116:119]
    s_cmp_ge_i32 s28, s29
    v_exp_f32 v240, v152
    v_mfma_f32_16x16x32_bf16 v[120:123], v[220:223], v[224:227], v[120:123]
    s_waitcnt lgkmcnt(0)
    v_exp_f32 v241, v153
    v_add_f32 v3, v3, v246
    v_mfma_f32_16x16x32_bf16 v[124:127], v[220:223], v[228:231], v[124:127]
    v_cvt_pk_bf16_f32 v237, v246, v247
    v_add_f32 v3, v3, v247
    s_cbranch_scc0 L_pent6
L_ok6:
L_body7:
    v_mfma_f32_16x16x32_bf16 v[128:131], v[160:163], v[32:35], v[24:27]
    ds_read_b64_tr_b16 v[192:193], v16 offset:57344
    ds_read_b64_tr_b16 v[194:195], v16 offset:61440
    v_exp_f32 v242, v156
    v_mfma_f32_16x16x32_bf16 v[132:135], v[160:163], v[48:51], v[28:31]
    ds_read_b64_tr_b16 v[196:197], v17 offset:57344
    ds_read_b64_tr_b16 v[198:199], v17 offset:61440
    v_exp_f32 v243, v157
    v_mfma_f32_16x16x32_bf16 v[136:139], v[164:167], v[32:35], v[248:251]
    ds_read_b64_tr_b16 v[200:201], v18 offset:57344
    v_add_f32 v2, v2, v240
    v_cvt_pk_bf16_f32 v234, v240, v241
    v_mfma_f32_16x16x32_bf16 v[140:143], v[164:167], v[48:51], v[252:255]
    ds_read_b64_tr_b16 v[202:203], v18 offset:61440
    v_add_f32 v2, v2, v241
    v_mfma_f32_16x16x32_bf16 v[128:131], v[168:171], v[36:39], v[128:131]
    ds_read_b64_tr_b16 v[204:205], v19 offset:57344
    v_exp_f32 v244, v154
    v_mfma_f32_16x16x32_bf16 v[132:135], v[168:171], v[52:55], v[132:135]
    ds_read_b64_tr_b16 v[206:207], v19 offset:61440
    v_exp_f32 v245, v155
    v_mfma_f32_16x16x32_bf16 v[136:139], v[172:175], v[36:39], v[136:139]
    ds_read_b64_tr_b16 v[208:209], v20 offset:57344
    v_add_f32 v3, v3, v242
    v_cvt_pk_bf16_f32 v238, v242, v243
    v_mfma_f32_16x16x32_bf16 v[140:143], v[172:175], v[52:55], v[140:143]
    ds_read_b64_tr_b16 v[210:211], v20 offset:61440
    v_add_f32 v3, v3, v243
    v_mfma_f32_16x16x32_bf16 v[128:131], v[176:179], v[40:43], v[128:131]
    ds_read_b64_tr_b16 v[212:213], v21 offset:57344
    v_exp_f32 v246, v158
    v_mfma_f32_16x16x32_bf16 v[132:135], v[176:179], v[56:59], v[132:135]
    ds_read_b64_tr_b16 v[214:215], v21 offset:61440
    v_exp_f32 v247, v159
    v_add_f32 v2, v2, v244
    v_mfma_f32_16x16x32_bf16 v[136:139], v[180:183], v[40:43], v[136:139]
    ds_read_b64_tr_b16 v[216:217], v22 offset:57344
    v_cvt_pk_bf16_f32 v235, v244, v245
    v_mfma_f32_16x16x32_bf16 v[140:143], v[180:183], v[56:59], v[140:143]
    ds_read_b64_tr_b16 v[218:219], v22 offset:61440
    v_add_f32 v2, v2, v245
    v_add_f32 v3, v3, v246
    v_mfma_f32_16x16x32_bf16 v[128:131], v[184:187], v[44:47], v[128:131]
    ds_read_b64_tr_b16 v[220:221], v23 offset:57344
    v_cvt_pk_bf16_f32 v239, v246, v247
    v_add_f32 v3, v3, v247
    v_mfma_f32_16x16x32_bf16 v[132:135], v[184:187], v[60:63], v[132:135]
    ds_read_b64_tr_b16 v[222:223], v23 offset:61440
    v_add_f32 v11, v2, v3
    v_cmp_nge_f32 vcc, s27, v11
    v_mfma_f32_16x16x32_bf16 v[136:139], v[188:191], v[44:47], v[136:139]
    ds_read_b128 v[160:163], v12 offset:8192
    ds_read_b128 v[164:167], v12 offset:12288
    v_mfma_f32_16x16x32_bf16 v[140:143], v[188:191], v[60:63], v[140:143]
    s_waitcnt lgkmcnt(6)
    ds_read_b128 v[168:171], v13 offset:8192
    s_cbranch_vccnz L_stub7
L_cont7:
    v_mfma_f32_16x16x32_bf16 v[64:67], v[192:195], v[232:235], v[64:67]
    ds_read_b128 v[172:175], v13 offset:12288
    v_add_f32 v5, v5, v2
    v_mfma_f32_16x16x32_bf16 v[68:71], v[192:195], v[236:239], v[68:71]
    ds_read_b128 v[176:179], v14 offset:8192
    v_add_f32 v7, v7, v3
    v_mfma_f32_16x16x32_bf16 v[72:75], v[196:199], v[232:235], v[72:75]
    ds_read_b128 v[180:183], v14 offset:12288
    v_add_u32 v9, 1, v9
    v_mfma_f32_16x16x32_bf16 v[76:79], v[196:199], v[236:239], v[76:79]
    ds_read_b128 v[184:187], v15 offset:8192
    v_exp_f32 v240, v128
    v_mfma_f32_16x16x32_bf16 v[80:83], v[200:203], v[232:235], v[80:83]
    ds_read_b128 v[188:191], v15 offset:12288
    v_exp_f32 v241, v129
    v_mfma_f32_16x16x32_bf16 v[84:87], v[200:203], v[236:239], v[84:87]
    s_waitcnt lgkmcnt(8)
    ds_write_b32 v8, v9
    v_exp_f32 v242, v132
    v_mfma_f32_16x16x32_bf16 v[88:91], v[204:207], v[232:235], v[88:91]
    v_exp_f32 v243, v133
    v_add_f32 v2, v240, v241
    v_mfma_f32_16x16x32_bf16 v[92:95], v[204:207], v[236:239], v[92:95]
    v_cvt_pk_bf16_f32 v224, v240, v241
    v_exp_f32 v244, v130
    v_mfma_f32_16x16x32_bf16 v[96:99], v[208:211], v[232:235], v[96:99]
    v_exp_f32 v245, v131
    v_mfma_f32_16x16x32_bf16 v[100:103], v[208:211], v[236:239], v[100:103]
    v_add_f32 v3, v242, v243
    v_cvt_pk_bf16_f32 v228, v242, v243
    v_mfma_f32_16x16x32_bf16 v[104:107], v[212:215], v[232:235], v[104:107]
    v_exp_f32 v246, v134
    v_mfma_f32_16x16x32_bf16 v[108:111], v[212:215], v[236:239], v[108:111]
    v_exp_f32 v247, v135
    v_add_f32 v2, v2, v244
    v_mfma_f32_16x16x32_bf16 v[112:115], v[216:219], v[232:235], v[112:115]
    s_add_u32 s29, s29, 2
    v_cvt_pk_bf16_f32 v225, v244, v245
    v_add_f32 v2, v2, v245
    v_mfma_f32_16x16x32_bf16 v[116:119], v[216:219], v[236:239], v[116:119]
    s_cmp_ge_i32 s28, s29
    v_exp_f32 v240, v136
    v_mfma_f32_16x16x32_bf16 v[120:123], v[220:223], v[232:235], v[120:123]
    s_waitcnt lgkmcnt(0)
    v_exp_f32 v241, v137
    v_add_f32 v3, v3, v246
    v_mfma_f32_16x16x32_bf16 v[124:127], v[220:223], v[236:239], v[124:127]
    v_cvt_pk_bf16_f32 v229, v246, v247
    v_add_f32 v3, v3, v247
    s_cbranch_scc1 L_body0
    s_branch L_pent7
L_fin:
    ds_read_b32 v10, v1 offset:4
    v_lshlrev_b32 v12, 4, v0
    s_add_u32 s34, s24, s3
    s_and_b32 s34, s34, 7
    s_lshl_b32 s34, s34, 13
    s_lshl_b32 s35, s3, 10
    s_add_u32 s35, s35, 131072
    v_add_u32 v13, s35, v12
    v_add_u32 v14, s34, v12
    v_mov_b32 v240, v5
    v_mov_b32 v241, v7
    s_nop 1
    v_permlane16_swap_b32 v240, v5
    v_permlane16_swap_b32 v241, v7
    s_nop 1
    v_add_f32 v5, v5, v240
    v_add_f32 v7, v7, v241
    v_mov_b32 v240, v5
    v_mov_b32 v241, v7
    s_nop 1
    v_permlane32_swap_b32 v240, v5
    v_permlane32_swap_b32 v241, v7
    s_nop 1
    v_add_f32 v5, v5, v240
    v_add_f32 v7, v7, v241
    s_cmp_eq_u32 s23, 0
    s_cbranch_scc0 L_send
    s_waitcnt lgkmcnt(0)
    v_readfirstlane_b32 s35, v10
    s_cmp_gt_u32 s35, s3
    s_cbranch_scc0 L_role
L_roleok:
    ds_read_b128 v[16:19], v13
    ds_read_b128 v[160:163], v14 offset:0
    ds_read_b128 v[164:167], v14 offset:1024
    ds_read_b128 v[168:171], v14 offset:2048
    ds_read_b128 v[172:175], v14 offset:3072
    ds_read_b128 v[176:179], v14 offset:4096
    ds_read_b128 v[180:183], v14 offset:5120
    ds_read_b128 v[184:187], v14 offset:6144
    ds_read_b128 v[188:191], v14 offset:7168
    v_and_b32 v24, 15, v0
    v_lshrrev_b32 v25, 4, v0
    v_lshlrev_b32 v26, 8, v24
    v_lshrrev_b32 v28, 1, v25
    v_xor_b32 v28, v28, v24
    v_lshl_add_u32 v28, v28, 4, v26
    v_and_b32 v29, 1, v25
    v_lshl_add_u32 v28, v29, 3, v28
    v_add_u32 v28, s34, v28
    s_waitcnt lgkmcnt(8)
    v_max_f32 v240, v4, v16
    v_sub_f32 v20, v4, v240
    v_sub_f32 v128, v16, v240
    v_exp_f32 v20, v20
    v_exp_f32 v128, v128
    v_max_f32 v241, v6, v18
    v_sub_f32 v22, v6, v241
    v_sub_f32 v130, v18, v241
    v_exp_f32 v22, v22
    v_exp_f32 v130, v130
    v_mul_f32 v240, v5, v20
    v_fma_f32 v240, v17, v128, v240
    v_mul_f32 v241, v7, v22
    v_fma_f32 v241, v19, v130, v241
    v_rcp_f32 v240, v240
    v_rcp_f32 v241, v241
    v_xor_b32 v29, v24, v25
    v_lshlrev_b32 v29, 4, v29
    v_lshl_add_u32 v29, v25, 8, v29
    v_add_u32 v29, s34, v29
    v_mul_f32 v20, v20, v240
    v_mul_f32 v128, v128, v240
    v_mov_b32 v21, v20
    v_mov_b32 v129, v128
    v_mul_f32 v22, v22, v241
    v_mul_f32 v130, v130, v241
    v_mov_b32 v23, v22
    v_mov_b32 v131, v130
    v_xor_b32 v144, 0, v28
    v_xor_b32 v145, 32, v28
    v_xor_b32 v146, 64, v28
    v_xor_b32 v147, 96, v28
    v_xor_b32 v148, 128, v28
    v_xor_b32 v149, 160, v28
    v_xor_b32 v150, 192, v28
    v_xor_b32 v151, 224, v28
    v_xor_b32 v152, 0, v29
    v_xor_b32 v153, 64, v29
    v_xor_b32 v154, 128, v29
    v_xor_b32 v155, 192, v29
    s_mov_b32 s40, s16
    s_mov_b32 s41, s17
    s_mov_b32 s42, 0x400000
    s_mov_b32 s43, 0x20000
    s_add_u32 s35, s33, 4096
    s_waitcnt lgkmcnt(0)
    v_lshlrev_b32 v132, 16, v160
    v_and_b32 v133, 0xffff0000, v160
    v_lshlrev_b32 v134, 16, v161
    v_and_b32 v135, 0xffff0000, v161
    v_pk_mul_f32 v[64:65], v[64:65], v[20:21]
    v_pk_mul_f32 v[66:67], v[66:67], v[20:21]
    v_pk_fma_f32 v[64:65], v[132:133], v[128:129], v[64:65]
    v_pk_fma_f32 v[66:67], v[134:135], v[128:129], v[66:67]
    v_cvt_pk_bf16_f32 v224, v64, v65
    v_cvt_pk_bf16_f32 v225, v66, v67
    v_lshlrev_b32 v136, 16, v164
    v_and_b32 v137, 0xffff0000, v164
    v_lshlrev_b32 v138, 16, v165
    v_and_b32 v139, 0xffff0000, v165
    v_pk_mul_f32 v[72:73], v[72:73], v[20:21]
    v_pk_mul_f32 v[74:75], v[74:75], v[20:21]
    v_pk_fma_f32 v[72:73], v[136:137], v[128:129], v[72:73]
    v_pk_fma_f32 v[74:75], v[138:139], v[128:129], v[74:75]
    v_cvt_pk_bf16_f32 v226, v72, v73
    v_cvt_pk_bf16_f32 v227, v74, v75
    v_lshlrev_b32 v132, 16, v168
    v_and_b32 v133, 0xffff0000, v168
    v_lshlrev_b32 v134, 16, v169
    v_and_b32 v135, 0xffff0000, v169
    v_pk_mul_f32 v[80:81], v[80:81], v[20:21]
    v_pk_mul_f32 v[82:83], v[82:83], v[20:21]
    v_pk_fma_f32 v[80:81], v[132:133], v[128:129], v[80:81]
    v_pk_fma_f32 v[82:83], v[134:135], v[128:129], v[82:83]
    v_cvt_pk_bf16_f32 v228, v80, v81
    v_cvt_pk_bf16_f32 v229, v82, v83
    v_lshlrev_b32 v136, 16, v172
    v_and_b32 v137, 0xffff0000, v172
    v_lshlrev_b32 v138, 16, v173
    v_and_b32 v139, 0xffff0000, v173
    v_pk_mul_f32 v[88:89], v[88:89], v[20:21]
    v_pk_mul_f32 v[90:91], v[90:91], v[20:21]
    v_pk_fma_f32 v[88:89], v[136:137], v[128:129], v[88:89]
    v_pk_fma_f32 v[90:91], v[138:139], v[128:129], v[90:91]
    v_cvt_pk_bf16_f32 v230, v88, v89
    v_cvt_pk_bf16_f32 v231, v90, v91
    v_lshlrev_b32 v132, 16, v176
    v_and_b32 v133, 0xffff0000, v176
    v_lshlrev_b32 v134, 16, v177
    v_and_b32 v135, 0xffff0000, v177
    v_pk_mul_f32 v[96:97], v[96:97], v[20:21]
    v_pk_mul_f32 v[98:99], v[98:99], v[20:21]
    v_pk_fma_f32 v[96:97], v[132:133], v[128:129], v[96:97]
    v_pk_fma_f32 v[98:99], v[134:135], v[128:129], v[98:99]
    v_cvt_pk_bf16_f32 v232, v96, v97
    v_cvt_pk_bf16_f32 v233, v98, v99
    v_lshlrev_b32 v136, 16, v180
    v_and_b32 v137, 0xffff0000, v180
    v_lshlrev_b32 v138, 16, v181
    v_and_b32 v139, 0xffff0000, v181
    v_pk_mul_f32 v[104:105], v[104:105], v[20:21]
    v_pk_mul_f32 v[106:107], v[106:107], v[20:21]
    v_pk_fma_f32 v[104:105], v[136:137], v[128:129], v[104:105]
    v_pk_fma_f32 v[106:107], v[138:139], v[128:129], v[106:107]
    v_cvt_pk_bf16_f32 v234, v104, v105
    v_cvt_pk_bf16_f32 v235, v106, v107
    v_lshlrev_b32 v132, 16, v184
    v_and_b32 v133, 0xffff0000, v184
    v_lshlrev_b32 v134, 16, v185
    v_and_b32 v135, 0xffff0000, v185
    v_pk_mul_f32 v[112:113], v[112:113], v[20:21]
    v_pk_mul_f32 v[114:115], v[114:115], v[20:21]
    v_pk_fma_f32 v[112:113], v[132:133], v[128:129], v[112:113]
    v_pk_fma_f32 v[114:115], v[134:135], v[128:129], v[114:115]
    v_cvt_pk_bf16_f32 v236, v112, v113
    v_cvt_pk_bf16_f32 v237, v114, v115
    v_lshlrev_b32 v136, 16, v188
    v_and_b32 v137, 0xffff0000, v188
    v_lshlrev_b32 v138, 16, v189
    v_and_b32 v139, 0xffff0000, v189
    v_pk_mul_f32 v[120:121], v[120:121], v[20:21]
    v_pk_mul_f32 v[122:123], v[122:123], v[20:21]
    v_pk_fma_f32 v[120:121], v[136:137], v[128:129], v[120:121]
    v_pk_fma_f32 v[122:123], v[138:139], v[128:129], v[122:123]
    v_cvt_pk_bf16_f32 v238, v120, v121
    v_cvt_pk_bf16_f32 v239, v122, v123
    ds_write_b64 v144, v[224:225] offset:0
    ds_write_b64 v145, v[226:227] offset:0
    ds_write_b64 v146, v[228:229] offset:0
    ds_write_b64 v147, v[230:231] offset:0
    ds_write_b64 v148, v[232:233] offset:0
    ds_write_b64 v149, v[234:235] offset:0
    ds_write_b64 v150, v[236:237] offset:0
    ds_write_b64 v151, v[238:239] offset:0
    ds_read_b128 v[192:195], v152 offset:0
    ds_read_b128 v[196:199], v153 offset:1024
    ds_read_b128 v[200:203], v154 offset:2048
    ds_read_b128 v[204:207], v155 offset:3072
    v_lshlrev_b32 v132, 16, v162
    v_and_b32 v133, 0xffff0000, v162
    v_lshlrev_b32 v134, 16, v163
    v_and_b32 v135, 0xffff0000, v163
    v_pk_mul_f32 v[68:69], v[68:69], v[22:23]
    v_pk_mul_f32 v[70:71], v[70:71], v[22:23]
    v_pk_fma_f32 v[68:69], v[132:133], v[130:131], v[68:69]
    v_pk_fma_f32 v[70:71], v[134:135], v[130:131], v[70:71]
    v_cvt_pk_bf16_f32 v224, v68, v69
    v_cvt_pk_bf16_f32 v225, v70, v71
    v_lshlrev_b32 v136, 16, v166
    v_and_b32 v137, 0xffff0000, v166
    v_lshlrev_b32 v138, 16, v167
    v_and_b32 v139, 0xffff0000, v167
    v_pk_mul_f32 v[76:77], v[76:77], v[22:23]
    v_pk_mul_f32 v[78:79], v[78:79], v[22:23]
    v_pk_fma_f32 v[76:77], v[136:137], v[130:131], v[76:77]
    v_pk_fma_f32 v[78:79], v[138:139], v[130:131], v[78:79]
    v_cvt_pk_bf16_f32 v226, v76, v77
    v_cvt_pk_bf16_f32 v227, v78, v79
    v_lshlrev_b32 v132, 16, v170
    v_and_b32 v133, 0xffff0000, v170
    v_lshlrev_b32 v134, 16, v171
    v_and_b32 v135, 0xffff0000, v171
    v_pk_mul_f32 v[84:85], v[84:85], v[22:23]
    v_pk_mul_f32 v[86:87], v[86:87], v[22:23]
    v_pk_fma_f32 v[84:85], v[132:133], v[130:131], v[84:85]
    v_pk_fma_f32 v[86:87], v[134:135], v[130:131], v[86:87]
    v_cvt_pk_bf16_f32 v228, v84, v85
    v_cvt_pk_bf16_f32 v229, v86, v87
    v_lshlrev_b32 v136, 16, v174
    v_and_b32 v137, 0xffff0000, v174
    v_lshlrev_b32 v138, 16, v175
    v_and_b32 v139, 0xffff0000, v175
    v_pk_mul_f32 v[92:93], v[92:93], v[22:23]
    v_pk_mul_f32 v[94:95], v[94:95], v[22:23]
    v_pk_fma_f32 v[92:93], v[136:137], v[130:131], v[92:93]
    v_pk_fma_f32 v[94:95], v[138:139], v[130:131], v[94:95]
    v_cvt_pk_bf16_f32 v230, v92, v93
    v_cvt_pk_bf16_f32 v231, v94, v95
    s_waitcnt lgkmcnt(0)
    buffer_store_dwordx4 v[192:195], v12, s[40:43], s33 offen offset:0 sc1
    buffer_store_dwordx4 v[196:199], v12, s[40:43], s33 offen offset:1024 sc1
    buffer_store_dwordx4 v[200:203], v12, s[40:43], s33 offen offset:2048 sc1
    buffer_store_dwordx4 v[204:207], v12, s[40:43], s33 offen offset:3072 sc1
    v_lshlrev_b32 v132, 16, v178
    v_and_b32 v133, 0xffff0000, v178
    v_lshlrev_b32 v134, 16, v179
    v_and_b32 v135, 0xffff0000, v179
    v_pk_mul_f32 v[100:101], v[100:101], v[22:23]
    v_pk_mul_f32 v[102:103], v[102:103], v[22:23]
    v_pk_fma_f32 v[100:101], v[132:133], v[130:131], v[100:101]
    v_pk_fma_f32 v[102:103], v[134:135], v[130:131], v[102:103]
    v_cvt_pk_bf16_f32 v232, v100, v101
    v_cvt_pk_bf16_f32 v233, v102, v103
    v_lshlrev_b32 v136, 16, v182
    v_and_b32 v137, 0xffff0000, v182
    v_lshlrev_b32 v138, 16, v183
    v_and_b32 v139, 0xffff0000, v183
    v_pk_mul_f32 v[108:109], v[108:109], v[22:23]
    v_pk_mul_f32 v[110:111], v[110:111], v[22:23]
    v_pk_fma_f32 v[108:109], v[136:137], v[130:131], v[108:109]
    v_pk_fma_f32 v[110:111], v[138:139], v[130:131], v[110:111]
    v_cvt_pk_bf16_f32 v234, v108, v109
    v_cvt_pk_bf16_f32 v235, v110, v111
    v_lshlrev_b32 v132, 16, v186
    v_and_b32 v133, 0xffff0000, v186
    v_lshlrev_b32 v134, 16, v187
    v_and_b32 v135, 0xffff0000, v187
    v_pk_mul_f32 v[116:117], v[116:117], v[22:23]
    v_pk_mul_f32 v[118:119], v[118:119], v[22:23]
    v_pk_fma_f32 v[116:117], v[132:133], v[130:131], v[116:117]
    v_pk_fma_f32 v[118:119], v[134:135], v[130:131], v[118:119]
    v_cvt_pk_bf16_f32 v236, v116, v117
    v_cvt_pk_bf16_f32 v237, v118, v119
    v_lshlrev_b32 v136, 16, v190
    v_and_b32 v137, 0xffff0000, v190
    v_lshlrev_b32 v138, 16, v191
    v_and_b32 v139, 0xffff0000, v191
    v_pk_mul_f32 v[124:125], v[124:125], v[22:23]
    v_pk_mul_f32 v[126:127], v[126:127], v[22:23]
    v_pk_fma_f32 v[124:125], v[136:137], v[130:131], v[124:125]
    v_pk_fma_f32 v[126:127], v[138:139], v[130:131], v[126:127]
    v_cvt_pk_bf16_f32 v238, v124, v125
    v_cvt_pk_bf16_f32 v239, v126, v127
    ds_write_b64 v144, v[224:225] offset:4096
    ds_write_b64 v145, v[226:227] offset:4096
    ds_write_b64 v146, v[228:229] offset:4096
    ds_write_b64 v147, v[230:231] offset:4096
    ds_write_b64 v148, v[232:233] offset:4096
    ds_write_b64 v149, v[234:235] offset:4096
    ds_write_b64 v150, v[236:237] offset:4096
    ds_write_b64 v151, v[238:239] offset:4096
    ds_read_b128 v[208:211], v152 offset:4096
    ds_read_b128 v[212:215], v153 offset:5120
    ds_read_b128 v[216:219], v154 offset:6144
    ds_read_b128 v[220:223], v155 offset:7168
    s_waitcnt lgkmcnt(3)
    buffer_store_dwordx4 v[208:211], v12, s[40:43], s35 offen offset:0 sc1
    s_waitcnt lgkmcnt(2)
    buffer_store_dwordx4 v[212:215], v12, s[40:43], s35 offen offset:1024 sc1
    s_waitcnt lgkmcnt(1)
    buffer_store_dwordx4 v[216:219], v12, s[40:43], s35 offen offset:2048 sc1
    s_waitcnt lgkmcnt(0)
    buffer_store_dwordx4 v[220:223], v12, s[40:43], s35 offen offset:3072 sc1
L_done:
L_end1:
    s_endpgm
L_role:
    ds_read_b32 v10, v1 offset:4
    s_sub_u32 s25, s25, 1
    s_cbranch_scc1 L_end1
    s_waitcnt lgkmcnt(0)
    v_readfirstlane_b32 s35, v10
    s_cmp_gt_u32 s35, s3
    s_cbranch_scc0 L_role
    s_branch L_roleok
L_send:
    s_mov_b32 s44, s20
    s_mov_b32 s45, s21
    s_mov_b32 s46, 0x4000000
    s_mov_b32 s47, 0x20000
    s_mul_i32 s35, s22, 36864
    s_add_u32 s35, s35, 1048576
    s_lshl_b32 s34, s3, 10
    s_add_u32 s34, s34, s35
    s_add_u32 s34, s34, 32768
    buffer_store_dwordx4 v[4:7], v12, s[44:47], s34 offen sc1
    s_lshl_b32 s34, s3, 13
    s_add_u32 s35, s35, s34
    v_cvt_pk_bf16_f32 v160, v64, v65
    v_cvt_pk_bf16_f32 v161, v66, v67
    v_cvt_pk_bf16_f32 v162, v68, v69
    v_cvt_pk_bf16_f32 v163, v70, v71
    buffer_store_dwordx4 v[160:163], v12, s[44:47], s35 offen offset:0 sc1
    v_cvt_pk_bf16_f32 v164, v72, v73
    v_cvt_pk_bf16_f32 v165, v74, v75
    v_cvt_pk_bf16_f32 v166, v76, v77
    v_cvt_pk_bf16_f32 v167, v78, v79
    buffer_store_dwordx4 v[164:167], v12, s[44:47], s35 offen offset:1024 sc1
    v_cvt_pk_bf16_f32 v168, v80, v81
    v_cvt_pk_bf16_f32 v169, v82, v83
    v_cvt_pk_bf16_f32 v170, v84, v85
    v_cvt_pk_bf16_f32 v171, v86, v87
    buffer_store_dwordx4 v[168:171], v12, s[44:47], s35 offen offset:2048 sc1
    v_cvt_pk_bf16_f32 v172, v88, v89
    v_cvt_pk_bf16_f32 v173, v90, v91
    v_cvt_pk_bf16_f32 v174, v92, v93
    v_cvt_pk_bf16_f32 v175, v94, v95
    buffer_store_dwordx4 v[172:175], v12, s[44:47], s35 offen offset:3072 sc1
    v_cvt_pk_bf16_f32 v176, v96, v97
    v_cvt_pk_bf16_f32 v177, v98, v99
    v_cvt_pk_bf16_f32 v178, v100, v101
    v_cvt_pk_bf16_f32 v179, v102, v103
    s_add_u32 s35, s35, 4096
    buffer_store_dwordx4 v[176:179], v12, s[44:47], s35 offen offset:0 sc1
    v_cvt_pk_bf16_f32 v180, v104, v105
    v_cvt_pk_bf16_f32 v181, v106, v107
    v_cvt_pk_bf16_f32 v182, v108, v109
    v_cvt_pk_bf16_f32 v183, v110, v111
    buffer_store_dwordx4 v[180:183], v12, s[44:47], s35 offen offset:1024 sc1
    v_cvt_pk_bf16_f32 v184, v112, v113
    v_cvt_pk_bf16_f32 v185, v114, v115
    v_cvt_pk_bf16_f32 v186, v116, v117
    v_cvt_pk_bf16_f32 v187, v118, v119
    buffer_store_dwordx4 v[184:187], v12, s[44:47], s35 offen offset:2048 sc1
    v_cvt_pk_bf16_f32 v188, v120, v121
    v_cvt_pk_bf16_f32 v189, v122, v123
    v_cvt_pk_bf16_f32 v190, v124, v125
    v_cvt_pk_bf16_f32 v191, v126, v127
    buffer_store_dwordx4 v[188:191], v12, s[44:47], s35 offen offset:3072 sc1
    s_lshl_b32 s35, s22, 7
    s_lshl_b32 s34, s3, 3
    s_add_u32 s35, s35, s34
    s_add_u32 s35, s35, 33554432
    v_mov_b32 v16, 0
L_sclr:
    ds_read_b64 v[14:15], v1 offset:32
    s_sub_u32 s25, s25, 1
    s_cbranch_scc1 L_end1
    s_waitcnt lgkmcnt(0)
    v_readfirstlane_b32 s34, v14
    s_cmp_eq_u32 s34, 0
    s_cbranch_scc1 L_sclr
    s_waitcnt vmcnt(0)
    s_mov_b64 exec, 1
    buffer_store_dwordx2 v[14:15], v16, s[44:47], s35 offen sc1
    s_mov_b64 exec, -1
    s_branch L_done
L_pent0:
    s_cmp_eq_u32 s29, s32
    s_cbranch_scc1 L_fin
L_poll0:
    ds_read_b32 v10, v1
    s_sub_u32 s25, s25, 1
    s_cbranch_scc1 L_end1
    s_waitcnt lgkmcnt(0)
    v_readfirstlane_b32 s28, v10
    s_cmp_ge_i32 s28, s29
    s_cbranch_scc1 L_ok0
    s_sleep 1
    s_branch L_poll0
L_pent1:
    s_cmp_eq_u32 s29, s32
    s_cbranch_scc1 L_fin
L_poll1:
    ds_read_b32 v10, v1
    s_sub_u32 s25, s25, 1
    s_cbranch_scc1 L_end1
    s_waitcnt lgkmcnt(0)
    v_readfirstlane_b32 s28, v10
    s_cmp_ge_i32 s28, s29
    s_cbranch_scc1 L_ok1
    s_sleep 1
    s_branch L_poll1
L_pent2:
    s_cmp_eq_u32 s29, s32
    s_cbranch_scc1 L_fin
L_poll2:
    ds_read_b32 v10, v1
    s_sub_u32 s25, s25, 1
    s_cbranch_scc1 L_end1
    s_waitcnt lgkmcnt(0)
    v_readfirstlane_b32 s28, v10
    s_cmp_ge_i32 s28, s29
    s_cbranch_scc1 L_ok2
    s_sleep 1
    s_branch L_poll2
L_pent3:
    s_cmp_eq_u32 s29, s32
    s_cbranch_scc1 L_fin
L_poll3:
    ds_read_b32 v10, v1
    s_sub_u32 s25, s25, 1
    s_cbranch_scc1 L_end1
    s_waitcnt lgkmcnt(0)
    v_readfirstlane_b32 s28, v10
    s_cmp_ge_i32 s28, s29
    s_cbranch_scc1 L_ok3
    s_sleep 1
    s_branch L_poll3
L_pent4:
    s_cmp_eq_u32 s29, s32
    s_cbranch_scc1 L_fin
L_poll4:
    ds_read_b32 v10, v1
    s_sub_u32 s25, s25, 1
    s_cbranch_scc1 L_end1
    s_waitcnt lgkmcnt(0)
    v_readfirstlane_b32 s28, v10
    s_cmp_ge_i32 s28, s29
    s_cbranch_scc1 L_ok4
    s_sleep 1
    s_branch L_poll4
L_pent5:
    s_cmp_eq_u32 s29, s32
    s_cbranch_scc1 L_fin
L_poll5:
    ds_read_b32 v10, v1
    s_sub_u32 s25, s25, 1
    s_cbranch_scc1 L_end1
    s_waitcnt lgkmcnt(0)
    v_readfirstlane_b32 s28, v10
    s_cmp_ge_i32 s28, s29
    s_cbranch_scc1 L_ok5
    s_sleep 1
    s_branch L_poll5
L_pent6:
    s_cmp_eq_u32 s29, s32
    s_cbranch_scc1 L_fin
L_poll6:
    ds_read_b32 v10, v1
    s_sub_u32 s25, s25, 1
    s_cbranch_scc1 L_end1
    s_waitcnt lgkmcnt(0)
    v_readfirstlane_b32 s28, v10
    s_cmp_ge_i32 s28, s29
    s_cbranch_scc1 L_ok6
    s_sleep 1
    s_branch L_poll6
L_pent7:
    s_cmp_eq_u32 s29, s32
    s_cbranch_scc1 L_fin
L_poll7:
    ds_read_b32 v10, v1
    s_sub_u32 s25, s25, 1
    s_cbranch_scc1 L_end1
    s_waitcnt lgkmcnt(0)
    v_readfirstlane_b32 s28, v10
    s_cmp_ge_i32 s28, s29
    s_cbranch_scc1 L_body0
    s_sleep 1
    s_branch L_poll7
L_stub0:
    s_call_b64 s[62:63], L_slowA
    s_branch L_cont0
L_stub1:
    s_call_b64 s[62:63], L_slowB
    s_branch L_cont1
L_stub2:
    s_call_b64 s[62:63], L_slowA
    s_branch L_cont2
L_stub3:
    s_call_b64 s[62:63], L_slowB
    s_branch L_cont3
L_stub4:
    s_call_b64 s[62:63], L_slowA
    s_branch L_cont4
L_stub5:
    s_call_b64 s[62:63], L_slowB
    s_branch L_cont5
L_stub6:
    s_call_b64 s[62:63], L_slowA
    s_branch L_cont6
L_stub7:
    s_call_b64 s[62:63], L_slowB
    s_branch L_cont7
L_slowA:
    v_max3_f32 v240, v128, v129, v130
    v_max3_f32 v240, v240, v131, v136
    v_max3_f32 v240, v240, v137, v138
    v_max_f32 v240, v240, v139
    v_max3_f32 v241, v132, v133, v134
    v_max3_f32 v241, v241, v135, v140
    v_max3_f32 v241, v241, v141, v142
    v_max_f32 v241, v241, v143
    v_mov_b32 v242, v240
    v_mov_b32 v243, v241
    s_nop 1
    v_permlane16_swap_b32 v242, v240
    v_permlane16_swap_b32 v243, v241
    s_nop 1
    v_max_f32 v240, v240, v242
    v_max_f32 v241, v241, v243
    v_mov_b32 v242, v240
    v_mov_b32 v243, v241
    s_nop 1
    v_permlane32_swap_b32 v242, v240
    v_permlane32_swap_b32 v243, v241
    s_nop 1
    v_max_f32 v240, v240, v242
    v_max_f32 v241, v241, v243
    v_max_f32 v240, s31, v240
    v_max_f32 v242, 0, v240
    v_exp_f32 v242, -v242
    v_add_f32 v4, v4, v240
    v_max_f32 v241, s31, v241
    v_max_f32 v243, 0, v241
    v_exp_f32 v243, -v243
    v_add_f32 v6, v6, v241
    s_mov_b32 s31, 0
    v_sub_f32 v128, v128, v240
    v_sub_f32 v144, v144, v240
    v_sub_f32 v129, v129, v240
    v_sub_f32 v145, v145, v240
    v_sub_f32 v130, v130, v240
    v_sub_f32 v146, v146, v240
    v_sub_f32 v131, v131, v240
    v_sub_f32 v147, v147, v240
    v_sub_f32 v132, v132, v241
    v_sub_f32 v148, v148, v241
    v_sub_f32 v133, v133, v241
    v_sub_f32 v149, v149, v241
    v_sub_f32 v134, v134, v241
    v_sub_f32 v150, v150, v241
    v_sub_f32 v135, v135, v241
    v_sub_f32 v151, v151, v241
    v_sub_f32 v136, v136, v240
    v_sub_f32 v152, v152, v240
    v_sub_f32 v137, v137, v240
    v_sub_f32 v153, v153, v240
    v_sub_f32 v138, v138, v240
    v_sub_f32 v154, v154, v240
    v_sub_f32 v139, v139, v240
    v_sub_f32 v155, v155, v240
    v_sub_f32 v140, v140, v241
    v_sub_f32 v156, v156, v241
    v_sub_f32 v141, v141, v241
    v_sub_f32 v157, v157, v241
    v_sub_f32 v142, v142, v241
    v_sub_f32 v158, v158, v241
    v_sub_f32 v143, v143, v241
    v_sub_f32 v159, v159, v241
    v_sub_f32 v24, 0, v4
    v_sub_f32 v25, 0, v4
    v_sub_f32 v26, 0, v4
    v_sub_f32 v27, 0, v4
    v_sub_f32 v28, 0, v6
    v_sub_f32 v29, 0, v6
    v_sub_f32 v30, 0, v6
    v_sub_f32 v31, 0, v6
    v_sub_f32 v248, 0, v4
    v_sub_f32 v249, 0, v4
    v_sub_f32 v250, 0, v4
    v_sub_f32 v251, 0, v4
    v_sub_f32 v252, 0, v6
    v_sub_f32 v253, 0, v6
    v_sub_f32 v254, 0, v6
    v_sub_f32 v255, 0, v6
    v_mul_f32 v5, v5, v242
    v_mul_f32 v7, v7, v243
    v_mul_f32 v64, v64, v242
    v_mul_f32 v65, v65, v242
    v_mul_f32 v66, v66, v242
    v_mul_f32 v67, v67, v242
    v_mul_f32 v68, v68, v243
    v_mul_f32 v69, v69, v243
    v_mul_f32 v70, v70, v243
    v_mul_f32 v71, v71, v243
    v_mul_f32 v72, v72, v242
    v_mul_f32 v73, v73, v242
    v_mul_f32 v74, v74, v242
    v_mul_f32 v75, v75, v242
    v_mul_f32 v76, v76, v243
    v_mul_f32 v77, v77, v243
    v_mul_f32 v78, v78, v243
    v_mul_f32 v79, v79, v243
    v_mul_f32 v80, v80, v242
    v_mul_f32 v81, v81, v242
    v_mul_f32 v82, v82, v242
    v_mul_f32 v83, v83, v242
    v_mul_f32 v84, v84, v243
    v_mul_f32 v85, v85, v243
    v_mul_f32 v86, v86, v243
    v_mul_f32 v87, v87, v243
    v_mul_f32 v88, v88, v242
    v_mul_f32 v89, v89, v242
    v_mul_f32 v90, v90, v242
    v_mul_f32 v91, v91, v242
    v_mul_f32 v92, v92, v243
    v_mul_f32 v93, v93, v243
    v_mul_f32 v94, v94, v243
    v_mul_f32 v95, v95, v243
    v_mul_f32 v96, v96, v242
    v_mul_f32 v97, v97, v242
    v_mul_f32 v98, v98, v242
    v_mul_f32 v99, v99, v242
    v_mul_f32 v100, v100, v243
    v_mul_f32 v101, v101, v243
    v_mul_f32 v102, v102, v243
    v_mul_f32 v103, v103, v243
    v_mul_f32 v104, v104, v242
    v_mul_f32 v105, v105, v242
    v_mul_f32 v106, v106, v242
    v_mul_f32 v107, v107, v242
    v_mul_f32 v108, v108, v243
    v_mul_f32 v109, v109, v243
    v_mul_f32 v110, v110, v243
    v_mul_f32 v111, v111, v243
    v_mul_f32 v112, v112, v242
    v_mul_f32 v113, v113, v242
    v_mul_f32 v114, v114, v242
    v_mul_f32 v115, v115, v242
    v_mul_f32 v116, v116, v243
    v_mul_f32 v117, v117, v243
    v_mul_f32 v118, v118, v243
    v_mul_f32 v119, v119, v243
    v_mul_f32 v120, v120, v242
    v_mul_f32 v121, v121, v242
    v_mul_f32 v122, v122, v242
    v_mul_f32 v123, v123, v242
    v_mul_f32 v124, v124, v243
    v_mul_f32 v125, v125, v243
    v_mul_f32 v126, v126, v243
    v_mul_f32 v127, v127, v243
    v_exp_f32 v240, v128
    v_exp_f32 v241, v129
    v_exp_f32 v242, v132
    v_exp_f32 v243, v133
    v_add_f32 v2, v240, v241
    v_cvt_pk_bf16_f32 v224, v240, v241
    v_exp_f32 v244, v130
    v_exp_f32 v245, v131
    v_add_f32 v3, v242, v243
    v_cvt_pk_bf16_f32 v228, v242, v243
    v_exp_f32 v246, v134
    v_exp_f32 v247, v135
    v_add_f32 v2, v2, v244
    v_cvt_pk_bf16_f32 v225, v244, v245
    v_add_f32 v2, v2, v245
    v_exp_f32 v240, v136
    v_exp_f32 v241, v137
    v_add_f32 v3, v3, v246
    v_cvt_pk_bf16_f32 v229, v246, v247
    v_add_f32 v3, v3, v247
    v_exp_f32 v242, v140
    v_exp_f32 v243, v141
    v_add_f32 v2, v2, v240
    v_cvt_pk_bf16_f32 v226, v240, v241
    v_add_f32 v2, v2, v241
    v_exp_f32 v244, v138
    v_exp_f32 v245, v139
    v_add_f32 v3, v3, v242
    v_cvt_pk_bf16_f32 v230, v242, v243
    v_add_f32 v3, v3, v243
    v_exp_f32 v246, v142
    v_exp_f32 v247, v143
    v_add_f32 v2, v2, v244
    v_cvt_pk_bf16_f32 v227, v244, v245
    v_add_f32 v2, v2, v245
    v_add_f32 v3, v3, v246
    v_cvt_pk_bf16_f32 v231, v246, v247
    v_add_f32 v3, v3, v247
    s_setpc_b64 s[62:63]
L_slowB:
    v_max3_f32 v240, v144, v145, v146
    v_max3_f32 v240, v240, v147, v152
    v_max3_f32 v240, v240, v153, v154
    v_max_f32 v240, v240, v155
    v_max3_f32 v241, v148, v149, v150
    v_max3_f32 v241, v241, v151, v156
    v_max3_f32 v241, v241, v157, v158
    v_max_f32 v241, v241, v159
    v_mov_b32 v242, v240
    v_mov_b32 v243, v241
    s_nop 1
    v_permlane16_swap_b32 v242, v240
    v_permlane16_swap_b32 v243, v241
    s_nop 1
    v_max_f32 v240, v240, v242
    v_max_f32 v241, v241, v243
    v_mov_b32 v242, v240
    v_mov_b32 v243, v241
    s_nop 1
    v_permlane32_swap_b32 v242, v240
    v_permlane32_swap_b32 v243, v241
    s_nop 1
    v_max_f32 v240, v240, v242
    v_max_f32 v241, v241, v243
    v_max_f32 v240, s31, v240
    v_max_f32 v242, 0, v240
    v_exp_f32 v242, -v242
    v_add_f32 v4, v4, v240
    v_max_f32 v241, s31, v241
    v_max_f32 v243, 0, v241
    v_exp_f32 v243, -v243
    v_add_f32 v6, v6, v241
    s_mov_b32 s31, 0
    v_sub_f32 v144, v144, v240
    v_sub_f32 v128, v128, v240
    v_sub_f32 v145, v145, v240
    v_sub_f32 v129, v129, v240
    v_sub_f32 v146, v146, v240
    v_sub_f32 v130, v130, v240
    v_sub_f32 v147, v147, v240
    v_sub_f32 v131, v131, v240
    v_sub_f32 v148, v148, v241
    v_sub_f32 v132, v132, v241
    v_sub_f32 v149, v149, v241
    v_sub_f32 v133, v133, v241
    v_sub_f32 v150, v150, v241
    v_sub_f32 v134, v134, v241
    v_sub_f32 v151, v151, v241
    v_sub_f32 v135, v135, v241
    v_sub_f32 v152, v152, v240
    v_sub_f32 v136, v136, v240
    v_sub_f32 v153, v153, v240
    v_sub_f32 v137, v137, v240
    v_sub_f32 v154, v154, v240
    v_sub_f32 v138, v138, v240
    v_sub_f32 v155, v155, v240
    v_sub_f32 v139, v139, v240
    v_sub_f32 v156, v156, v241
    v_sub_f32 v140, v140, v241
    v_sub_f32 v157, v157, v241
    v_sub_f32 v141, v141, v241
    v_sub_f32 v158, v158, v241
    v_sub_f32 v142, v142, v241
    v_sub_f32 v159, v159, v241
    v_sub_f32 v143, v143, v241
    v_sub_f32 v24, 0, v4
    v_sub_f32 v25, 0, v4
    v_sub_f32 v26, 0, v4
    v_sub_f32 v27, 0, v4
    v_sub_f32 v28, 0, v6
    v_sub_f32 v29, 0, v6
    v_sub_f32 v30, 0, v6
    v_sub_f32 v31, 0, v6
    v_sub_f32 v248, 0, v4
    v_sub_f32 v249, 0, v4
    v_sub_f32 v250, 0, v4
    v_sub_f32 v251, 0, v4
    v_sub_f32 v252, 0, v6
    v_sub_f32 v253, 0, v6
    v_sub_f32 v254, 0, v6
    v_sub_f32 v255, 0, v6
    v_mul_f32 v5, v5, v242
    v_mul_f32 v7, v7, v243
    v_mul_f32 v64, v64, v242
    v_mul_f32 v65, v65, v242
    v_mul_f32 v66, v66, v242
    v_mul_f32 v67, v67, v242
    v_mul_f32 v68, v68, v243
    v_mul_f32 v69, v69, v243
    v_mul_f32 v70, v70, v243
    v_mul_f32 v71, v71, v243
    v_mul_f32 v72, v72, v242
    v_mul_f32 v73, v73, v242
    v_mul_f32 v74, v74, v242
    v_mul_f32 v75, v75, v242
    v_mul_f32 v76, v76, v243
    v_mul_f32 v77, v77, v243
    v_mul_f32 v78, v78, v243
    v_mul_f32 v79, v79, v243
    v_mul_f32 v80, v80, v242
    v_mul_f32 v81, v81, v242
    v_mul_f32 v82, v82, v242
    v_mul_f32 v83, v83, v242
    v_mul_f32 v84, v84, v243
    v_mul_f32 v85, v85, v243
    v_mul_f32 v86, v86, v243
    v_mul_f32 v87, v87, v243
    v_mul_f32 v88, v88, v242
    v_mul_f32 v89, v89, v242
    v_mul_f32 v90, v90, v242
    v_mul_f32 v91, v91, v242
    v_mul_f32 v92, v92, v243
    v_mul_f32 v93, v93, v243
    v_mul_f32 v94, v94, v243
    v_mul_f32 v95, v95, v243
    v_mul_f32 v96, v96, v242
    v_mul_f32 v97, v97, v242
    v_mul_f32 v98, v98, v242
    v_mul_f32 v99, v99, v242
    v_mul_f32 v100, v100, v243
    v_mul_f32 v101, v101, v243
    v_mul_f32 v102, v102, v243
    v_mul_f32 v103, v103, v243
    v_mul_f32 v104, v104, v242
    v_mul_f32 v105, v105, v242
    v_mul_f32 v106, v106, v242
    v_mul_f32 v107, v107, v242
    v_mul_f32 v108, v108, v243
    v_mul_f32 v109, v109, v243
    v_mul_f32 v110, v110, v243
    v_mul_f32 v111, v111, v243
    v_mul_f32 v112, v112, v242
    v_mul_f32 v113, v113, v242
    v_mul_f32 v114, v114, v242
    v_mul_f32 v115, v115, v242
    v_mul_f32 v116, v116, v243
    v_mul_f32 v117, v117, v243
    v_mul_f32 v118, v118, v243
    v_mul_f32 v119, v119, v243
    v_mul_f32 v120, v120, v242
    v_mul_f32 v121, v121, v242
    v_mul_f32 v122, v122, v242
    v_mul_f32 v123, v123, v242
    v_mul_f32 v124, v124, v243
    v_mul_f32 v125, v125, v243
    v_mul_f32 v126, v126, v243
    v_mul_f32 v127, v127, v243
    v_exp_f32 v240, v144
    v_exp_f32 v241, v145
    v_exp_f32 v242, v148
    v_exp_f32 v243, v149
    v_add_f32 v2, v240, v241
    v_cvt_pk_bf16_f32 v232, v240, v241
    v_exp_f32 v244, v146
    v_exp_f32 v245, v147
    v_add_f32 v3, v242, v243
    v_cvt_pk_bf16_f32 v236, v242, v243
    v_exp_f32 v246, v150
    v_exp_f32 v247, v151
    v_add_f32 v2, v2, v244
    v_cvt_pk_bf16_f32 v233, v244, v245
    v_add_f32 v2, v2, v245
    v_exp_f32 v240, v152
    v_exp_f32 v241, v153
    v_add_f32 v3, v3, v246
    v_cvt_pk_bf16_f32 v237, v246, v247
    v_add_f32 v3, v3, v247
    v_exp_f32 v242, v156
    v_exp_f32 v243, v157
    v_add_f32 v2, v2, v240
    v_cvt_pk_bf16_f32 v234, v240, v241
    v_add_f32 v2, v2, v241
    v_exp_f32 v244, v154
    v_exp_f32 v245, v155
    v_add_f32 v3, v3, v242
    v_cvt_pk_bf16_f32 v238, v242, v243
    v_add_f32 v3, v3, v243
    v_exp_f32 v246, v158
    v_exp_f32 v247, v159
    v_add_f32 v2, v2, v244
    v_cvt_pk_bf16_f32 v235, v244, v245
    v_add_f32 v2, v2, v245
    v_add_f32 v3, v3, v246
    v_cvt_pk_bf16_f32 v239, v246, v247
    v_add_f32 v3, v3, v247
    s_setpc_b64 s[62:63]
L_codeend:
.section .rodata,"a"
.p2align 6
.amdhsa_kernel standalone__tree_speculative_verify_tree_attention_over_candidate_token_tree__sampling_kernel
.amdhsa_next_free_vgpr 256
.amdhsa_next_free_sgpr 96
.amdhsa_accum_offset 256
.amdhsa_group_segment_fixed_size 0
.amdhsa_kernarg_size 72
.amdhsa_user_sgpr_count 2
.amdhsa_user_sgpr_kernarg_segment_ptr 1
.amdhsa_system_sgpr_workgroup_id_x 1
.end_amdhsa_kernel
```
